```python
import torch

def _softmax(x, axis=-1):
    return torch.softmax(x, dim=axis)
def _gelu(x):
    return torch.nn.functional.gelu(x, approximate="tanh")
def _silu(x):
    return torch.nn.functional.silu(x)
def _sigmoid(x):
    return torch.sigmoid(x)
def _layernorm(x, axis=-1, eps=1e-5):
    m = x.mean(dim=axis, keepdim=True)
    v = x.var(dim=axis, keepdim=True, unbiased=False)
    return (x - m) / torch.sqrt(v + eps)
def _scatter_add(tgt, idx, src, axis=0):
    return tgt.clone().index_add_(axis, idx, src)
def _segment_sum(src, seg, n):
    out = torch.zeros((n,) + src.shape[1:], dtype=src.dtype)
    return out.index_add_(0, seg, src)
def _pad(x, pw):
    flat = tuple(v for pair in reversed(pw) for v in pair)
    return torch.nn.functional.pad(x, flat)

kernel_name = 'standalone__mha_block_cached__near_ridge'

def setup_inputs():

    _w = (lambda a: (lambda t: t.to(torch.bfloat16) if t.is_floating_point() else t)(torch.as_tensor(a)))
    B, Sq, D = 8, 224, 448
    H, Sk, Dh = 16, 1024, 256
    return {
        "x": _w((lambda *s: torch.randn(*s, dtype=torch.bfloat16) * 0.8)(B, Sq, D)),
        "k_cache": _w((lambda *s: torch.randn(*s, dtype=torch.bfloat16) * 0.8)(B, H, Sk, Dh)),
        "v_cache": _w((lambda *s: torch.randn(*s, dtype=torch.bfloat16) * 0.05)(B, H, Sk, Dh)),
        "wq": _w((lambda *s: torch.randn(*s, dtype=torch.bfloat16) * 0.8)(D, H * Dh) * (D ** -0.5)),
        "wo": _w((lambda *s: torch.randn(*s, dtype=torch.bfloat16) * 0.05)(H * Dh, D) * ((H * Dh) ** -0.5)),
    }

def reference(x, k_cache, v_cache, wq, wo):
    B, Sq, D = x.shape
    H, Dh = 16, 256
    q = (lambda x, *d: x.permute(*d))((x @ wq).reshape(B, Sq, H, Dh), 0, 2, 1, 3)
    scores = torch.einsum("bhqd,bhkd->bhqk", q, k_cache) * (Dh ** -0.5)
    p = _softmax(scores, axis=-1)
    o = torch.einsum("bhqk,bhkd->bhqd", p, v_cache)
    return (lambda x, *d: x.permute(*d))(o, 0, 2, 1, 3).reshape(B, Sq, H * Dh) @ wo
```

```asm
; @launch grid=(256,1,1) block=(256,1,1) lds=163840
.amdgcn_target "amdgcn-amd-amdhsa--gfx950"
.text
.globl standalone__mha_block_cached__near_ridge_kernel
.p2align 8
.type standalone__mha_block_cached__near_ridge_kernel,@function
standalone__mha_block_cached__near_ridge_kernel:
    s_cmp_ge_u32 s2, 256
    s_cbranch_scc1 L_end
    s_mov_b32 s66, 0
L_restart:
    s_load_dwordx16 s[4:19], s[0:1], 0
    v_and_b32 v1, 63, v0
    v_lshrrev_b32 v2, 6, v0
    s_getpc_b64 s[80:81]
L_pc0:
    s_lshr_b32 s63, s2, 3
    s_lshl_b32 s63, s63, 10
    v_and_b32 v3, 1, v0
    v_lshlrev_b32 v3, 7, v3
    v_lshl_add_u32 v3, v2, 8, v3
    v_add_u32 v3, s63, v3
    v_min_u32 v3, L_last-L_pc0, v3
    global_load_dword v6, v3, s[80:81]
    s_and_b32 s58, s2, 3
    v_readfirstlane_b32 s56, v2
    s_bfe_u32 s59, s2, 0x10003
    s_bfe_u32 s65, s2, 0x20004
    s_lshl_b32 s58, s58, 2
    s_add_u32 s58, s58, s65
    s_bfe_u32 s57, s2, 0x10002
    s_lshl_b32 s57, s57, 2
    s_lshr_b32 s63, s2, 6
    s_add_u32 s57, s57, s63
    s_add_u32 s63, s63, s65
    s_lshl_b32 s63, s63, 1
    s_add_u32 s63, s63, s59
    s_sub_u32 s65, s63, 7
    s_cmp_ge_u32 s63, 7
    s_cselect_b32 s72, s65, s63
    s_lshl_b32 s64, s56, 13
    s_lshl_b32 s79, s57, 1
    s_add_u32 s79, s79, s59
    s_lshr_b32 s63, s2, 6
    s_lshl_b32 s63, s63, 1
    s_add_u32 s63, s63, s59
    s_bfe_u32 s65, s2, 0x20004
    s_add_u32 s63, s63, s65
    s_lshl_b32 s63, s63, 2
    s_mov_b32 s74, 0x20420420
    s_mov_b32 s75, 0x204
    s_lshr_b64 s[74:75], s[74:75], s63
    s_and_b32 s72, s74, 15
    v_lshrrev_b32 v5, 3, v1
    v_and_b32 v8, 7, v1
    v_lshl_add_u32 v254, v2, 5, v5
    v_mul_u32_u24 v254, 896, v254
    v_bfe_u32 v7, v1, 4, 2
    v_xor_b32 v255, v7, v8
    v_lshlrev_b32 v255, 4, v255
    v_add_u32 v240, v254, v255
    v_xor_b32 v255, 64, v255
    v_add_u32 v241, v254, v255
    v_add_u32 v241, 6144, v241
    v_add_u32 v242, 12288, v240
    v_add_u32 v243, 12288, v241
    v_lshlrev_b32 v7, 5, v7
    v_lshlrev_b32 v254, 4, v8
    v_xor_b32 v7, v7, v254
    v_lshrrev_b32 v254, 2, v5
    v_lshlrev_b32 v254, 3, v254
    v_and_b32 v255, 3, v5
    v_add_u32 v254, v254, v255
    v_lshlrev_b32 v254, 13, v254
    v_lshl_add_u32 v254, v2, 7, v254
    v_add_u32 v244, v254, v7
    v_add_u32 v245, 130048, v244
    v_add_u32 v246, 30720, v244
    v_add_u32 v247, 160768, v244
    s_mul_i32 s63, s79, 100352
    s_mov_b32 s22, 100352
    s_mov_b32 s23, 0x20000
    s_mov_b32 s27, 0x20000
    s_waitcnt lgkmcnt(0)
    s_add_u32 s20, s4, s63
    s_addc_u32 s21, s5, 0
    s_lshl_b32 s63, s56, 12
    s_add_u32 m0, s63, 114688
    s_lshl_b32 s65, s72, 7
    buffer_load_dwordx4 v240, s[20:23], s65 offen offset:0 lds
    buffer_load_dwordx4 v241, s[20:23], s65 offen offset:1024 lds
    buffer_load_dwordx4 v242, s[20:23], s65 offen offset:2048 lds
    buffer_load_dwordx4 v243, s[20:23], s65 offen offset:3072 lds
    s_lshl_b32 s63, s58, 9
    s_add_u32 s24, s10, s63
    s_addc_u32 s25, s11, 0
    s_sub_u32 s26, 3670016, s63
    s_or_b32 s63, s58, s66
    s_cbranch_scc1 L_nopw
    s_lshl_b32 s63, s79, 17
    s_add_u32 s63, s63, 54525952
    s_add_u32 s52, s18, s63
    s_addc_u32 s53, s19, 0
    s_mul_i32 s100, s56, 0x3000
    s_cmp_ge_u32 s56, 2
    s_cselect_b32 s63, 0x2000, 0
    s_sub_u32 s100, s100, s63
    s_add_u32 s100, s100, 2048
    s_xor_b32 s101, s100, 8192
    s_mov_b32 s99, 0
    s_atomic_add s99, s[52:53], s100
    s_atomic_add s99, s[52:53], s101
    L_nopw:
    s_add_u32 m0, s64, 65536
    s_lshl_b32 s65, s72, 19
    buffer_load_dwordx4 v244, s[24:27], s65 offen offset:0 lds
    buffer_load_dwordx4 v245, s[24:27], s65 offen offset:1024 lds
    buffer_load_dwordx4 v246, s[24:27], s65 offen offset:2048 lds
    buffer_load_dwordx4 v247, s[24:27], s65 offen offset:3072 lds
    s_add_u32 m0, s64, 69632
    s_add_u32 s65, s65, 262144
    buffer_load_dwordx4 v244, s[24:27], s65 offen offset:0 lds
    buffer_load_dwordx4 v245, s[24:27], s65 offen offset:1024 lds
    buffer_load_dwordx4 v246, s[24:27], s65 offen offset:2048 lds
    buffer_load_dwordx4 v247, s[24:27], s65 offen offset:3072 lds
    s_lshl_b32 s63, s57, 4
    s_add_u32 s63, s63, s58
    s_lshl_b32 s63, s63, 19
    s_sub_u32 s6, s6, 2048
    s_subb_u32 s7, s7, 0
    s_sub_u32 s8, s8, 2048
    s_subb_u32 s9, s9, 0
    s_add_u32 s28, s6, s63
    s_addc_u32 s29, s7, 0
    s_mov_b32 s30, 526336
    s_mov_b32 s31, 0x20000
    s_add_u32 s32, s8, s63
    s_addc_u32 s33, s9, 0
    s_mov_b32 s34, 526336
    s_mov_b32 s35, 0x20000
    s_mul_i32 s63, s58, 229376
    s_add_u32 s36, s12, s63
    s_addc_u32 s37, s13, 0
    s_mov_b32 s38, 229376
    s_mov_b32 s39, 0x20000
    s_lshl_b32 s63, s79, 17
    s_add_u32 s44, s18, s63
    s_addc_u32 s45, s19, 0
    s_mov_b32 s46, 50462720
    s_mov_b32 s47, 0x20000
    s_lshr_b32 s63, s58, 1
    s_lshl_b32 s63, s63, 14
    s_and_b32 s65, s58, 1
    s_lshl_b32 s65, s65, 12
    s_add_u32 s63, s63, s65
    s_add_u32 s40, s44, s63
    s_addc_u32 s41, s45, 0
    s_mov_b32 s42, 50343936
    s_mov_b32 s43, 0x20000
    s_mul_i32 s63, s79, 100352
    s_add_u32 s48, s14, s63
    s_addc_u32 s49, s15, 0
    s_mov_b32 s50, 100352
    s_mov_b32 s51, 0x20000
    s_add_u32 s52, s44, 54525952
    s_addc_u32 s53, s45, 0
    s_mov_b32 s54, 0x10000
    s_mov_b32 s55, 0x20000
    v_and_b32 v3, 15, v1
    v_lshrrev_b32 v4, 4, v1
    v_lshlrev_b32 v8, 4, v1
    v_mov_b32 v254, 0
    buffer_load_dword v6, v254, s[28:31], 0 offen offset:2048
    buffer_load_dword v6, v254, s[32:35], 0 offen offset:2048
    buffer_load_dword v6, v254, s[36:39], 0 offen offset:0
    s_mov_b32 s63, 0xff00
    buffer_load_dword v6, v254, s[52:55], s63 offen offset:0
    buffer_load_dword v6, v254, s[48:51], 0 offen offset:0
    s_or_b32 s63, s56, s58
    s_or_b32 s63, s63, s66
    s_cbranch_scc1 L_noclr
    v_mov_b32 v44, 0
    v_mov_b32 v45, 0
    v_mov_b32 v46, 0
    v_mov_b32 v47, 0
    s_movk_i32 s63, 0
    buffer_store_dwordx4 v[44:47], v8, s[52:55], s63 offen sc1
    s_movk_i32 s63, 8192
    buffer_store_dwordx4 v[44:47], v8, s[52:55], s63 offen sc1
    L_noclr:
    s_add_u32 s73, s72, 1
    s_cmp_eq_u32 s73, 7
    s_cselect_b32 s73, 0, s73
    s_add_u32 s74, s73, 1
    s_cmp_eq_u32 s74, 7
    s_cselect_b32 s74, 0, s74
    s_add_u32 s75, s74, 1
    s_cmp_eq_u32 s75, 7
    s_cselect_b32 s75, 0, s75
    s_add_u32 s76, s75, 1
    s_cmp_eq_u32 s76, 7
    s_cselect_b32 s76, 0, s76
    s_add_u32 s77, s76, 1
    s_cmp_eq_u32 s77, 7
    s_cselect_b32 s77, 0, s77
    s_add_u32 s78, s77, 1
    s_cmp_eq_u32 s78, 7
    s_cselect_b32 s78, 0, s78
    v_lshrrev_b32 v254, 2, v1
    v_lshlrev_b32 v254, 7, v254
    v_lshl_add_u32 v254, v2, 13, v254
    v_bfe_u32 v255, v1, 3, 2
    v_bfe_u32 v12, v1, 2, 2
    v_lshl_add_u32 v12, v4, 4, v12
    v_lshlrev_b32 v12, 7, v12
    v_lshl_add_u32 v12, v2, 13, v12
    v_lshl_add_u32 v12, v255, 5, v12
    v_and_b32 v13, 3, v1
    v_lshl_add_u32 v12, v13, 3, v12
    v_add_u32 v12, 0x10000, v12
    v_xor_b32 v13, 32, v12
    v_xor_b32 v14, 64, v12
    v_xor_b32 v15, 96, v12
    v_bfe_u32 v250, v1, 1, 1
    v_xor_b32 v255, v255, v250
    v_lshl_add_u32 v254, v255, 5, v254
    v_and_b32 v255, 1, v1
    v_lshl_add_u32 v250, v255, 4, v254
    v_xor_b32 v251, 64, v250
    v_add_u32 v252, 0x10000, v250
    v_add_u32 v253, 0x10000, v251
    v_lshrrev_b32 v255, 1, v3
    v_xor_b32 v255, v255, v4
    v_lshlrev_b32 v255, 4, v255
    v_lshl_add_u32 v255, v3, 7, v255
    v_add_u32 v248, 98304, v255
    v_xor_b32 v249, 64, v248
    v_lshlrev_b32 v254, 13, v2
    v_lshl_add_u32 v254, v3, 9, v254
    v_xor_b32 v255, v3, v4
    v_lshl_add_u32 v16, v255, 4, v254
    v_xor_b32 v17, 64, v16
    v_xor_b32 v18, 128, v16
    v_xor_b32 v19, 192, v16
    v_lshrrev_b32 v255, 5, v1
    v_lshlrev_b32 v254, 11, v2
    v_lshl_add_u32 v254, v255, 9, v254
    v_and_b32 v24, 31, v1
    v_xor_b32 v24, v24, v255
    v_lshl_add_u32 v24, v24, 4, v254
    v_xor_b32 v25, 32, v24
    v_xor_b32 v26, 64, v24
    v_xor_b32 v27, 96, v24
    v_xor_b32 v28, 128, v24
    v_xor_b32 v29, 160, v24
    v_xor_b32 v30, 192, v24
    v_xor_b32 v31, 224, v24
    s_mul_i32 s63, s59, 8192
    s_add_u32 s65, s63, 2048
    s_sub_u32 s63, 8192, s63
    v_add_u32 v24, s65, v24
    v_add_u32 v25, s65, v25
    v_add_u32 v26, s63, v26
    v_add_u32 v27, s63, v27
    v_add_u32 v28, s65, v28
    v_add_u32 v29, s65, v29
    v_add_u32 v30, s63, v30
    v_add_u32 v31, s63, v31
    v_lshlrev_b32 v254, 9, v5
    v_lshl_add_u32 v254, v2, 7, v254
    v_and_b32 v20, 7, v1
    v_lshlrev_b32 v20, 4, v20
    v_bfe_u32 v21, v1, 4, 1
    v_lshlrev_b32 v21, 5, v21
    v_xor_b32 v20, v20, v21
    v_xor_b32 v22, 64, v20
    v_add_u32 v20, v254, v20
    v_add_u32 v22, v254, v22
    v_add_u32 v20, s65, v20
    v_add_u32 v22, s63, v22
    v_add_u32 v21, 3072, v20
    v_add_u32 v23, 3072, v22
    v_add_u32 v10, 131072, v8
    v_lshrrev_b32 v254, 1, v2
    v_lshl_add_u32 v11, v254, 10, v10
    v_and_b32 v254, 1, v2
    v_lshl_add_u32 v11, v254, 3, v11
    v_lshlrev_b32 v9, 5, v3
    v_add_u32 v9, 159744, v9
    v_add_u32 v255, 65536, v8
    v_lshl_add_u32 v254, v2, 11, v255
    v_mov_b32 v32, 0xff800000
    v_mov_b32 v33, 0xff800000
    v_lshrrev_b32 v34, 1, v8
    v_add_u32 v34, 161792, v34
    s_mov_b32 s3, 0x3db8aa3b
    s_or_b32 s63, s58, s66
    s_cbranch_scc1 L_nopr
    s_mov_b32 s10, 0
    s_mov_b32 s11, 0
    s_waitcnt lgkmcnt(0)
    s_memtime s[4:5]
    s_atomic_add s10, s[52:53], s100 glc
    s_waitcnt lgkmcnt(0)
    s_memtime s[6:7]
    s_atomic_add s11, s[52:53], s101 glc
    s_waitcnt lgkmcnt(0)
    s_memtime s[8:9]
    s_waitcnt lgkmcnt(0)
    s_sub_u32 s10, s6, s4
    s_sub_u32 s11, s8, s6
    s_bitcmp1_b32 s100, 13
    s_cselect_b32 s63, s11, s10
    s_cselect_b32 s65, s10, s11
    v_mov_b32 v92, s63
    v_mov_b32 v93, s65
    v_lshlrev_b32 v94, 3, v2
    v_add_u32 v94, 98304, v94
    ds_write_b64 v94, v[92:93]
    s_waitcnt lgkmcnt(0)
    L_nopr:
    s_lshl_b32 s63, s56, 12
    s_add_u32 m0, s63, 131072
    s_lshl_b32 s65, s73, 7
    buffer_load_dwordx4 v240, s[20:23], s65 offen offset:0 lds
    buffer_load_dwordx4 v241, s[20:23], s65 offen offset:1024 lds
    buffer_load_dwordx4 v242, s[20:23], s65 offen offset:2048 lds
    buffer_load_dwordx4 v243, s[20:23], s65 offen offset:3072 lds
    s_add_u32 m0, s64, 0
    s_lshl_b32 s65, s73, 19
    buffer_load_dwordx4 v244, s[24:27], s65 offen offset:0 lds
    buffer_load_dwordx4 v245, s[24:27], s65 offen offset:1024 lds
    buffer_load_dwordx4 v246, s[24:27], s65 offen offset:2048 lds
    buffer_load_dwordx4 v247, s[24:27], s65 offen offset:3072 lds
    s_waitcnt vmcnt(17)
    s_barrier
    ds_read_b128 v[44:47], v248 offset:16384
    ds_read_b64_tr_b16 a[224:225], v252 offset:0
    ds_read_b64_tr_b16 a[226:227], v252 offset:2048
    ds_read_b64_tr_b16 a[232:233], v252 offset:8
    ds_read_b64_tr_b16 a[234:235], v252 offset:2056
    ds_read_b64_tr_b16 a[240:241], v253 offset:0
    ds_read_b64_tr_b16 a[242:243], v253 offset:2048
    ds_read_b64_tr_b16 a[248:249], v253 offset:8
    ds_read_b64_tr_b16 a[250:251], v253 offset:2056
    ds_read_b128 v[48:51], v248 offset:18432
    ds_read_b128 v[52:55], v248 offset:20480
    ds_read_b128 v[56:59], v248 offset:22528
    s_waitcnt lgkmcnt(9)
    v_mfma_f32_16x16x32_bf16 v[128:131], a[224:227], v[44:47], 0
    s_waitcnt lgkmcnt(3)
    v_mfma_f32_16x16x32_bf16 v[132:135], a[232:235], v[44:47], 0
    s_add_u32 m0, s64, 4096
    s_add_u32 s65, s65, 262144
    ds_read_b128 v[60:63], v248 offset:24576
    v_mfma_f32_16x16x32_bf16 v[136:139], a[240:243], v[44:47], 0
    buffer_load_dwordx4 v244, s[24:27], s65 offen offset:0 lds
    v_mfma_f32_16x16x32_bf16 v[140:143], a[248:251], v[44:47], 0
    s_waitcnt lgkmcnt(3)
    v_mfma_f32_16x16x32_bf16 v[144:147], a[224:227], v[48:51], 0
    buffer_load_dwordx4 v245, s[24:27], s65 offen offset:1024 lds
    v_mfma_f32_16x16x32_bf16 v[148:151], a[232:235], v[48:51], 0
    s_nop 0
    ds_read_b128 v[64:67], v248 offset:26624
    v_mfma_f32_16x16x32_bf16 v[152:155], a[240:243], v[48:51], 0
    buffer_load_dwordx4 v246, s[24:27], s65 offen offset:2048 lds
    v_mfma_f32_16x16x32_bf16 v[156:159], a[248:251], v[48:51], 0
    s_waitcnt lgkmcnt(2)
    v_mfma_f32_16x16x32_bf16 v[160:163], a[224:227], v[52:55], 0
    buffer_load_dwordx4 v247, s[24:27], s65 offen offset:3072 lds
    v_mfma_f32_16x16x32_bf16 v[164:167], a[232:235], v[52:55], 0
    s_lshl_b32 s63, s56, 12
    s_add_u32 m0, s63, 147456
    s_lshl_b32 s65, s74, 7
    ds_read_b128 v[68:71], v248 offset:28672
    v_mfma_f32_16x16x32_bf16 v[168:171], a[240:243], v[52:55], 0
    buffer_load_dwordx4 v240, s[20:23], s65 offen offset:0 lds
    v_mfma_f32_16x16x32_bf16 v[172:175], a[248:251], v[52:55], 0
    v_mfma_f32_16x16x32_bf16 v[176:179], a[224:227], v[56:59], 0
    s_waitcnt vmcnt(18)
    ds_read_b64_tr_b16 a[228:229], v252 offset:4096
    ds_read_b64_tr_b16 a[230:231], v252 offset:6144
    v_mfma_f32_16x16x32_bf16 v[180:183], a[232:235], v[56:59], 0
    s_nop 0
    ds_read_b128 v[72:75], v249 offset:16384
    ds_read_b64_tr_b16 a[236:237], v252 offset:4104
    v_mfma_f32_16x16x32_bf16 v[184:187], a[240:243], v[56:59], 0
    buffer_load_dwordx4 v241, s[20:23], s65 offen offset:1024 lds
    v_mfma_f32_16x16x32_bf16 v[188:191], a[248:251], v[56:59], 0
    s_waitcnt lgkmcnt(5)
    ds_read_b64_tr_b16 a[238:239], v252 offset:6152
    ds_read_b64_tr_b16 a[244:245], v253 offset:4096
    v_mfma_f32_16x16x32_bf16 v[192:195], a[224:227], v[60:63], 0
    s_nop 0
    ds_read_b64_tr_b16 a[246:247], v253 offset:6144
    ds_read_b64_tr_b16 a[252:253], v253 offset:4104
    v_mfma_f32_16x16x32_bf16 v[196:199], a[232:235], v[60:63], 0
    s_nop 0
    ds_read_b128 v[44:47], v249 offset:18432
    ds_read_b64_tr_b16 a[254:255], v253 offset:6152
    v_mfma_f32_16x16x32_bf16 v[200:203], a[240:243], v[60:63], 0
    buffer_load_dwordx4 v242, s[20:23], s65 offen offset:2048 lds
    v_mfma_f32_16x16x32_bf16 v[204:207], a[248:251], v[60:63], 0
    v_mfma_f32_16x16x32_bf16 v[208:211], a[224:227], v[64:67], 0
    v_mfma_f32_16x16x32_bf16 v[212:215], a[232:235], v[64:67], 0
    s_nop 0
    ds_read_b128 v[48:51], v249 offset:20480
    v_mfma_f32_16x16x32_bf16 v[216:219], a[240:243], v[64:67], 0
    buffer_load_dwordx4 v243, s[20:23], s65 offen offset:3072 lds
    v_mfma_f32_16x16x32_bf16 v[220:223], a[248:251], v[64:67], 0
    s_waitcnt lgkmcnt(5)
    v_mfma_f32_16x16x32_bf16 v[224:227], a[224:227], v[68:71], 0
    v_mfma_f32_16x16x32_bf16 v[228:231], a[232:235], v[68:71], 0
    s_add_u32 m0, s64, 32768
    s_lshl_b32 s65, s74, 19
    ds_read_b128 v[52:55], v249 offset:22528
    v_mfma_f32_16x16x32_bf16 v[232:235], a[240:243], v[68:71], 0
    buffer_load_dwordx4 v244, s[24:27], s65 offen offset:0 lds
    v_mfma_f32_16x16x32_bf16 v[236:239], a[248:251], v[68:71], 0
    v_mfma_f32_16x16x32_bf16 v[128:131], a[228:231], v[72:75], v[128:131]
    v_mfma_f32_16x16x32_bf16 v[132:135], a[236:239], v[72:75], v[132:135]
    s_waitcnt lgkmcnt(1)
    ds_read_b128 v[56:59], v249 offset:24576
    v_mfma_f32_16x16x32_bf16 v[136:139], a[244:247], v[72:75], v[136:139]
    buffer_load_dwordx4 v245, s[24:27], s65 offen offset:1024 lds
    v_mfma_f32_16x16x32_bf16 v[140:143], a[252:255], v[72:75], v[140:143]
    v_mfma_f32_16x16x32_bf16 v[144:147], a[228:231], v[44:47], v[144:147]
    v_mfma_f32_16x16x32_bf16 v[148:151], a[236:239], v[44:47], v[148:151]
    s_nop 0
    ds_read_b128 v[60:63], v249 offset:26624
    v_mfma_f32_16x16x32_bf16 v[152:155], a[244:247], v[44:47], v[152:155]
    buffer_load_dwordx4 v246, s[24:27], s65 offen offset:2048 lds
    v_mfma_f32_16x16x32_bf16 v[156:159], a[252:255], v[44:47], v[156:159]
    s_waitcnt vmcnt(7)
    ds_read_b64_tr_b16 v[96:97], v250 offset:0
    ds_read_b64_tr_b16 v[98:99], v250 offset:2048
    v_mfma_f32_16x16x32_bf16 v[160:163], a[228:231], v[48:51], v[160:163]
    s_nop 0
    ds_read_b64_tr_b16 v[100:101], v250 offset:4096
    ds_read_b64_tr_b16 v[102:103], v250 offset:6144
    v_mfma_f32_16x16x32_bf16 v[164:167], a[236:239], v[48:51], v[164:167]
    s_waitcnt lgkmcnt(5)
    ds_read_b128 v[64:67], v249 offset:28672
    ds_read_b64_tr_b16 v[104:105], v250 offset:8
    v_mfma_f32_16x16x32_bf16 v[168:171], a[244:247], v[48:51], v[168:171]
    buffer_load_dwordx4 v247, s[24:27], s65 offen offset:3072 lds
    v_mfma_f32_16x16x32_bf16 v[172:175], a[252:255], v[48:51], v[172:175]
    s_nop 0
    ds_read_b64_tr_b16 v[106:107], v250 offset:2056
    ds_read_b64_tr_b16 v[108:109], v250 offset:4104
    v_mfma_f32_16x16x32_bf16 v[176:179], a[228:231], v[52:55], v[176:179]
    s_barrier
    s_add_u32 m0, s64, 36864
    ds_read_b64_tr_b16 v[110:111], v250 offset:6152
    v_mfma_f32_16x16x32_bf16 v[180:183], a[236:239], v[52:55], v[180:183]
    s_add_u32 s65, s65, 262144
    ds_read_b128 v[76:79], v248 offset:32768
    ds_read_b64_tr_b16 v[112:113], v251 offset:0
    v_mfma_f32_16x16x32_bf16 v[184:187], a[244:247], v[52:55], v[184:187]
    buffer_load_dwordx4 v244, s[24:27], s65 offen offset:0 lds
    v_mfma_f32_16x16x32_bf16 v[188:191], a[252:255], v[52:55], v[188:191]
    s_nop 0
    ds_read_b128 v[80:83], v249 offset:32768
    ds_read_b64_tr_b16 v[114:115], v251 offset:2048
    v_mfma_f32_16x16x32_bf16 v[192:195], a[228:231], v[56:59], v[192:195]
    s_or_b32 s62, s56, s58
    s_or_b32 s62, s62, s66
    s_cbranch_scc1 L_nocert
    s_lshl_b32 s62, s79, 2
    v_mov_b32 v35, s62
    ds_read_b128 v[36:39], v94
    ds_read_b128 v[92:95], v94 offset:16
    s_waitcnt lgkmcnt(0)
    v_min3_u32 v36, v36, v38, v92
    v_min3_u32 v37, v37, v39, v93
    v_min_u32 v36, v36, v94
    v_min_u32 v37, v37, v95
    v_mov_b32 v38, 8193
    v_cmp_gt_u32 vcc, v36, v37
    s_nop 1
    v_cndmask_b32 v43, 1, v38, vcc
    global_store_dword v35, v43, s[16:17] sc1
    L_nocert:
    s_nop 0
    s_nop 0
    v_mfma_f32_16x16x32_bf16 v[196:199], a[236:239], v[56:59], v[196:199]
    buffer_load_dwordx4 v245, s[24:27], s65 offen offset:1024 lds
    v_mfma_f32_16x16x32_bf16 v[200:203], a[244:247], v[56:59], v[200:203]
    s_nop 0
    ds_read_b64_tr_b16 v[116:117], v251 offset:4096
    v_mfma_f32_16x16x32_bf16 v[204:207], a[252:255], v[56:59], v[204:207]
    s_waitcnt lgkmcnt(6)
    ds_read_b64_tr_b16 v[118:119], v251 offset:6144
    ds_read_b64_tr_b16 v[120:121], v251 offset:8
    v_mfma_f32_16x16x32_bf16 v[208:211], a[228:231], v[60:63], v[208:211]
    s_nop 0
    ds_read_b64_tr_b16 v[122:123], v251 offset:2056
    v_mfma_f32_16x16x32_bf16 v[212:215], a[236:239], v[60:63], v[212:215]
    s_nop 0
    ds_read_b128 v[84:87], v248 offset:34816
    ds_read_b64_tr_b16 v[124:125], v251 offset:4104
    v_mfma_f32_16x16x32_bf16 v[216:219], a[244:247], v[60:63], v[216:219]
    buffer_load_dwordx4 v246, s[24:27], s65 offen offset:2048 lds
    v_mfma_f32_16x16x32_bf16 v[220:223], a[252:255], v[60:63], v[220:223]
    s_nop 0
    ds_read_b128 v[88:91], v249 offset:34816
    ds_read_b64_tr_b16 v[126:127], v251 offset:6152
    v_mfma_f32_16x16x32_bf16 v[224:227], a[228:231], v[64:67], v[224:227]
    buffer_load_dwordx4 v247, s[24:27], s65 offen offset:3072 lds
    v_mfma_f32_16x16x32_bf16 v[228:231], a[236:239], v[64:67], v[228:231]
    v_mfma_f32_16x16x32_bf16 v[232:235], a[244:247], v[64:67], v[232:235]
    s_waitcnt lgkmcnt(7)
    v_mfma_f32_16x16x32_bf16 v[236:239], a[252:255], v[64:67], v[236:239]
    s_lshl_b32 s63, s56, 12
    s_add_u32 m0, s63, 98304
    s_lshl_b32 s65, s75, 7
    v_mfma_f32_16x16x32_bf16 v[128:131], v[96:99], v[76:79], v[128:131]
    buffer_load_dwordx4 v240, s[20:23], s65 offen offset:0 lds
    v_mfma_f32_16x16x32_bf16 v[128:131], v[100:103], v[80:83], v[128:131]
    s_nop 0
    ds_read_b128 v[44:47], v248 offset:36864
    v_mfma_f32_16x16x32_bf16 v[132:135], v[104:107], v[76:79], v[132:135]
    v_mfma_f32_16x16x32_bf16 v[132:135], v[108:111], v[80:83], v[132:135]
    s_waitcnt lgkmcnt(1)
    ds_read_b128 v[48:51], v249 offset:36864
    v_mfma_f32_16x16x32_bf16 v[136:139], v[112:115], v[76:79], v[136:139]
    buffer_load_dwordx4 v241, s[20:23], s65 offen offset:1024 lds
    v_mfma_f32_16x16x32_bf16 v[136:139], v[116:119], v[80:83], v[136:139]
    v_mfma_f32_16x16x32_bf16 v[140:143], v[120:123], v[76:79], v[140:143]
    v_mfma_f32_16x16x32_bf16 v[140:143], v[124:127], v[80:83], v[140:143]
    v_mfma_f32_16x16x32_bf16 v[144:147], v[96:99], v[84:87], v[144:147]
    buffer_load_dwordx4 v242, s[20:23], s65 offen offset:2048 lds
    v_mfma_f32_16x16x32_bf16 v[144:147], v[100:103], v[88:91], v[144:147]
    s_nop 0
    ds_read_b128 v[52:55], v248 offset:38912
    v_mfma_f32_16x16x32_bf16 v[148:151], v[104:107], v[84:87], v[148:151]
    v_mfma_f32_16x16x32_bf16 v[148:151], v[108:111], v[88:91], v[148:151]
    s_nop 0
    ds_read_b128 v[56:59], v249 offset:38912
    v_mfma_f32_16x16x32_bf16 v[152:155], v[112:115], v[84:87], v[152:155]
    buffer_load_dwordx4 v243, s[20:23], s65 offen offset:3072 lds
    v_mfma_f32_16x16x32_bf16 v[152:155], v[116:119], v[88:91], v[152:155]
    v_mfma_f32_16x16x32_bf16 v[156:159], v[120:123], v[84:87], v[156:159]
    v_mfma_f32_16x16x32_bf16 v[156:159], v[124:127], v[88:91], v[156:159]
    s_waitcnt lgkmcnt(2)
    s_add_u32 m0, s64, 65536
    s_lshl_b32 s65, s75, 19
    v_mfma_f32_16x16x32_bf16 v[160:163], v[96:99], v[44:47], v[160:163]
    buffer_load_dwordx4 v244, s[24:27], s65 offen offset:0 lds
    v_mfma_f32_16x16x32_bf16 v[160:163], v[100:103], v[48:51], v[160:163]
    s_nop 0
    ds_read_b128 v[60:63], v248 offset:40960
    v_mfma_f32_16x16x32_bf16 v[164:167], v[104:107], v[44:47], v[164:167]
    v_mfma_f32_16x16x32_bf16 v[164:167], v[108:111], v[48:51], v[164:167]
    s_nop 0
    ds_read_b128 v[64:67], v249 offset:40960
    v_mfma_f32_16x16x32_bf16 v[168:171], v[112:115], v[44:47], v[168:171]
    buffer_load_dwordx4 v245, s[24:27], s65 offen offset:1024 lds
    v_mfma_f32_16x16x32_bf16 v[168:171], v[116:119], v[48:51], v[168:171]
    v_mfma_f32_16x16x32_bf16 v[172:175], v[120:123], v[44:47], v[172:175]
    v_mfma_f32_16x16x32_bf16 v[172:175], v[124:127], v[48:51], v[172:175]
    s_waitcnt lgkmcnt(2)
    v_mfma_f32_16x16x32_bf16 v[176:179], v[96:99], v[52:55], v[176:179]
    buffer_load_dwordx4 v246, s[24:27], s65 offen offset:2048 lds
    v_mfma_f32_16x16x32_bf16 v[176:179], v[100:103], v[56:59], v[176:179]
    s_waitcnt vmcnt(15)
    ds_read_b128 v[68:71], v248 offset:43008
    v_mfma_f32_16x16x32_bf16 v[180:183], v[104:107], v[52:55], v[180:183]
    s_barrier
    s_waitcnt vmcnt(7)
    ds_read_b64_tr_b16 a[224:225], v250 offset:32768
    v_mfma_f32_16x16x32_bf16 v[180:183], v[108:111], v[56:59], v[180:183]
    s_nop 0
    ds_read_b128 v[72:75], v249 offset:43008
    ds_read_b64_tr_b16 a[226:227], v250 offset:34816
    v_mfma_f32_16x16x32_bf16 v[184:187], v[112:115], v[52:55], v[184:187]
    buffer_load_dwordx4 v247, s[24:27], s65 offen offset:3072 lds
    v_mfma_f32_16x16x32_bf16 v[184:187], v[116:119], v[56:59], v[184:187]
    s_nop 0
    ds_read_b64_tr_b16 a[228:229], v250 offset:36864
    v_mfma_f32_16x16x32_bf16 v[188:191], v[120:123], v[52:55], v[188:191]
    s_waitcnt lgkmcnt(5)
    ds_read_b64_tr_b16 a[230:231], v250 offset:38912
    v_mfma_f32_16x16x32_bf16 v[188:191], v[124:127], v[56:59], v[188:191]
    s_add_u32 m0, s64, 69632
    s_add_u32 s65, s65, 262144
    ds_read_b64_tr_b16 a[232:233], v250 offset:32776
    v_mfma_f32_16x16x32_bf16 v[192:195], v[96:99], v[60:63], v[192:195]
    buffer_load_dwordx4 v244, s[24:27], s65 offen offset:0 lds
    v_mfma_f32_16x16x32_bf16 v[192:195], v[100:103], v[64:67], v[192:195]
    s_nop 0
    ds_read_b128 v[44:47], v248 offset:45056
    ds_read_b64_tr_b16 a[234:235], v250 offset:34824
    v_mfma_f32_16x16x32_bf16 v[196:199], v[104:107], v[60:63], v[196:199]
    s_nop 0
    ds_read_b64_tr_b16 a[236:237], v250 offset:36872
    v_mfma_f32_16x16x32_bf16 v[196:199], v[108:111], v[64:67], v[196:199]
    s_nop 0
    ds_read_b128 v[48:51], v249 offset:45056
    ds_read_b64_tr_b16 a[238:239], v250 offset:38920
    v_mfma_f32_16x16x32_bf16 v[200:203], v[112:115], v[60:63], v[200:203]
    buffer_load_dwordx4 v245, s[24:27], s65 offen offset:1024 lds
    v_mfma_f32_16x16x32_bf16 v[200:203], v[116:119], v[64:67], v[200:203]
    s_nop 0
    ds_read_b64_tr_b16 a[240:241], v251 offset:32768
    v_mfma_f32_16x16x32_bf16 v[204:207], v[120:123], v[60:63], v[204:207]
    s_waitcnt lgkmcnt(7)
    ds_read_b64_tr_b16 a[242:243], v251 offset:34816
    v_mfma_f32_16x16x32_bf16 v[204:207], v[124:127], v[64:67], v[204:207]
    buffer_load_dwordx4 v246, s[24:27], s65 offen offset:2048 lds
    v_mfma_f32_16x16x32_bf16 v[208:211], v[96:99], v[68:71], v[208:211]
    s_nop 0
    ds_read_b64_tr_b16 a[244:245], v251 offset:36864
    v_mfma_f32_16x16x32_bf16 v[208:211], v[100:103], v[72:75], v[208:211]
    s_nop 0
    ds_read_b128 v[52:55], v248 offset:49152
    ds_read_b64_tr_b16 a[246:247], v251 offset:38912
    v_mfma_f32_16x16x32_bf16 v[212:215], v[104:107], v[68:71], v[212:215]
    s_nop 0
    ds_read_b64_tr_b16 a[248:249], v251 offset:32776
    v_mfma_f32_16x16x32_bf16 v[212:215], v[108:111], v[72:75], v[212:215]
    s_nop 0
    ds_read_b128 v[56:59], v249 offset:49152
    ds_read_b64_tr_b16 a[250:251], v251 offset:34824
    v_mfma_f32_16x16x32_bf16 v[216:219], v[112:115], v[68:71], v[216:219]
    buffer_load_dwordx4 v247, s[24:27], s65 offen offset:3072 lds
    v_mfma_f32_16x16x32_bf16 v[216:219], v[116:119], v[72:75], v[216:219]
    s_waitcnt lgkmcnt(7)
    s_lshl_b32 s63, s56, 12
    ds_read_b64_tr_b16 a[252:253], v251 offset:36872
    v_mfma_f32_16x16x32_bf16 v[220:223], v[120:123], v[68:71], v[220:223]
    s_add_u32 m0, s63, 114688
    s_lshl_b32 s65, s76, 7
    ds_read_b64_tr_b16 a[254:255], v251 offset:38920
    v_mfma_f32_16x16x32_bf16 v[220:223], v[124:127], v[72:75], v[220:223]
    buffer_load_dwordx4 v240, s[20:23], s65 offen offset:0 lds
    v_mfma_f32_16x16x32_bf16 v[224:227], v[96:99], v[44:47], v[224:227]
    v_mfma_f32_16x16x32_bf16 v[224:227], v[100:103], v[48:51], v[224:227]
    s_nop 0
    ds_read_b128 v[60:63], v248 offset:51200
    v_mfma_f32_16x16x32_bf16 v[228:231], v[104:107], v[44:47], v[228:231]
    v_mfma_f32_16x16x32_bf16 v[228:231], v[108:111], v[48:51], v[228:231]
    s_nop 0
    ds_read_b128 v[64:67], v249 offset:51200
    v_mfma_f32_16x16x32_bf16 v[232:235], v[112:115], v[44:47], v[232:235]
    buffer_load_dwordx4 v241, s[20:23], s65 offen offset:1024 lds
    v_mfma_f32_16x16x32_bf16 v[232:235], v[116:119], v[48:51], v[232:235]
    v_mfma_f32_16x16x32_bf16 v[236:239], v[120:123], v[44:47], v[236:239]
    s_waitcnt lgkmcnt(2)
    v_mfma_f32_16x16x32_bf16 v[236:239], v[124:127], v[48:51], v[236:239]
    buffer_load_dwordx4 v242, s[20:23], s65 offen offset:2048 lds
    v_mfma_f32_16x16x32_bf16 v[128:131], a[224:227], v[52:55], v[128:131]
    v_mfma_f32_16x16x32_bf16 v[128:131], a[228:231], v[56:59], v[128:131]
    s_nop 0
    ds_read_b128 v[68:71], v248 offset:53248
    v_mfma_f32_16x16x32_bf16 v[132:135], a[232:235], v[52:55], v[132:135]
    v_mfma_f32_16x16x32_bf16 v[132:135], a[236:239], v[56:59], v[132:135]
    s_nop 0
    ds_read_b128 v[72:75], v249 offset:53248
    v_mfma_f32_16x16x32_bf16 v[136:139], a[240:243], v[52:55], v[136:139]
    buffer_load_dwordx4 v243, s[20:23], s65 offen offset:3072 lds
    v_mfma_f32_16x16x32_bf16 v[136:139], a[244:247], v[56:59], v[136:139]
    v_mfma_f32_16x16x32_bf16 v[140:143], a[248:251], v[52:55], v[140:143]
    s_waitcnt lgkmcnt(2)
    s_add_u32 m0, s64, 0
    s_lshl_b32 s65, s76, 19
    v_mfma_f32_16x16x32_bf16 v[140:143], a[252:255], v[56:59], v[140:143]
    buffer_load_dwordx4 v244, s[24:27], s65 offen offset:0 lds
    v_mfma_f32_16x16x32_bf16 v[144:147], a[224:227], v[60:63], v[144:147]
    v_mfma_f32_16x16x32_bf16 v[144:147], a[228:231], v[64:67], v[144:147]
    s_nop 0
    ds_read_b128 v[44:47], v248 offset:55296
    v_mfma_f32_16x16x32_bf16 v[148:151], a[232:235], v[60:63], v[148:151]
    v_mfma_f32_16x16x32_bf16 v[148:151], a[236:239], v[64:67], v[148:151]
    s_nop 0
    ds_read_b128 v[48:51], v249 offset:55296
    v_mfma_f32_16x16x32_bf16 v[152:155], a[240:243], v[60:63], v[152:155]
    buffer_load_dwordx4 v245, s[24:27], s65 offen offset:1024 lds
    v_mfma_f32_16x16x32_bf16 v[152:155], a[244:247], v[64:67], v[152:155]
    v_mfma_f32_16x16x32_bf16 v[156:159], a[248:251], v[60:63], v[156:159]
    buffer_load_dwordx4 v246, s[24:27], s65 offen offset:2048 lds
    v_mfma_f32_16x16x32_bf16 v[156:159], a[252:255], v[64:67], v[156:159]
    s_waitcnt lgkmcnt(2)
    v_mfma_f32_16x16x32_bf16 v[160:163], a[224:227], v[68:71], v[160:163]
    v_mfma_f32_16x16x32_bf16 v[160:163], a[228:231], v[72:75], v[160:163]
    s_nop 0
    ds_read_b128 v[52:55], v248 offset:57344
    v_mfma_f32_16x16x32_bf16 v[164:167], a[232:235], v[68:71], v[164:167]
    buffer_load_dwordx4 v247, s[24:27], s65 offen offset:3072 lds
    v_mfma_f32_16x16x32_bf16 v[164:167], a[236:239], v[72:75], v[164:167]
    s_nop 0
    ds_read_b128 v[56:59], v249 offset:57344
    v_mfma_f32_16x16x32_bf16 v[168:171], a[240:243], v[68:71], v[168:171]
    v_mfma_f32_16x16x32_bf16 v[168:171], a[244:247], v[72:75], v[168:171]
    s_add_u32 m0, s64, 4096
    s_add_u32 s65, s65, 262144
    v_mfma_f32_16x16x32_bf16 v[172:175], a[248:251], v[68:71], v[172:175]
    buffer_load_dwordx4 v244, s[24:27], s65 offen offset:0 lds
    v_mfma_f32_16x16x32_bf16 v[172:175], a[252:255], v[72:75], v[172:175]
    s_waitcnt lgkmcnt(2)
    v_mfma_f32_16x16x32_bf16 v[176:179], a[224:227], v[44:47], v[176:179]
    v_mfma_f32_16x16x32_bf16 v[176:179], a[228:231], v[48:51], v[176:179]
    s_waitcnt vmcnt(17)
    ds_read_b128 v[60:63], v248 offset:59392
    v_mfma_f32_16x16x32_bf16 v[180:183], a[232:235], v[44:47], v[180:183]
    s_barrier
    s_waitcnt vmcnt(9)
    ds_read_b64_tr_b16 v[96:97], v252 offset:0
    v_mfma_f32_16x16x32_bf16 v[180:183], a[236:239], v[48:51], v[180:183]
    s_nop 0
    ds_read_b128 v[64:67], v249 offset:59392
    ds_read_b64_tr_b16 v[98:99], v252 offset:2048
    v_mfma_f32_16x16x32_bf16 v[184:187], a[240:243], v[44:47], v[184:187]
    buffer_load_dwordx4 v245, s[24:27], s65 offen offset:1024 lds
    v_mfma_f32_16x16x32_bf16 v[184:187], a[244:247], v[48:51], v[184:187]
    s_nop 0
    ds_read_b64_tr_b16 v[100:101], v252 offset:4096
    v_mfma_f32_16x16x32_bf16 v[188:191], a[248:251], v[44:47], v[188:191]
    buffer_load_dwordx4 v246, s[24:27], s65 offen offset:2048 lds
    v_mfma_f32_16x16x32_bf16 v[188:191], a[252:255], v[48:51], v[188:191]
    s_waitcnt lgkmcnt(5)
    ds_read_b64_tr_b16 v[102:103], v252 offset:6144
    v_mfma_f32_16x16x32_bf16 v[192:195], a[224:227], v[52:55], v[192:195]
    s_nop 0
    ds_read_b64_tr_b16 v[104:105], v252 offset:8
    v_mfma_f32_16x16x32_bf16 v[192:195], a[228:231], v[56:59], v[192:195]
    s_nop 0
    ds_read_b128 v[68:71], v248 offset:61440
    ds_read_b64_tr_b16 v[106:107], v252 offset:2056
    v_mfma_f32_16x16x32_bf16 v[196:199], a[232:235], v[52:55], v[196:199]
    buffer_load_dwordx4 v247, s[24:27], s65 offen offset:3072 lds
    v_mfma_f32_16x16x32_bf16 v[196:199], a[236:239], v[56:59], v[196:199]
    s_nop 0
    ds_read_b128 v[72:75], v249 offset:61440
    ds_read_b64_tr_b16 v[108:109], v252 offset:4104
    v_mfma_f32_16x16x32_bf16 v[200:203], a[240:243], v[52:55], v[200:203]
    s_lshl_b32 s63, s56, 12
    ds_read_b64_tr_b16 v[110:111], v252 offset:6152
    v_mfma_f32_16x16x32_bf16 v[200:203], a[244:247], v[56:59], v[200:203]
    s_add_u32 m0, s63, 131072
    s_lshl_b32 s65, s77, 7
    ds_read_b64_tr_b16 v[112:113], v253 offset:0
    v_mfma_f32_16x16x32_bf16 v[204:207], a[248:251], v[52:55], v[204:207]
    buffer_load_dwordx4 v240, s[20:23], s65 offen offset:0 lds
    v_mfma_f32_16x16x32_bf16 v[204:207], a[252:255], v[56:59], v[204:207]
    s_waitcnt lgkmcnt(7)
    ds_read_b64_tr_b16 v[114:115], v253 offset:2048
    v_mfma_f32_16x16x32_bf16 v[208:211], a[224:227], v[60:63], v[208:211]
    s_nop 0
    ds_read_b64_tr_b16 v[116:117], v253 offset:4096
    v_mfma_f32_16x16x32_bf16 v[208:211], a[228:231], v[64:67], v[208:211]
    s_nop 0
    ds_read_b128 v[44:47], v248 offset:0
    ds_read_b64_tr_b16 v[118:119], v253 offset:6144
    v_mfma_f32_16x16x32_bf16 v[212:215], a[232:235], v[60:63], v[212:215]
    buffer_load_dwordx4 v241, s[20:23], s65 offen offset:1024 lds
    v_mfma_f32_16x16x32_bf16 v[212:215], a[236:239], v[64:67], v[212:215]
    s_nop 0
    ds_read_b128 v[48:51], v249 offset:0
    ds_read_b64_tr_b16 v[120:121], v253 offset:8
    v_mfma_f32_16x16x32_bf16 v[216:219], a[240:243], v[60:63], v[216:219]
    s_nop 0
    ds_read_b64_tr_b16 v[122:123], v253 offset:2056
    v_mfma_f32_16x16x32_bf16 v[216:219], a[244:247], v[64:67], v[216:219]
    s_nop 0
    ds_read_b64_tr_b16 v[124:125], v253 offset:4104
    v_mfma_f32_16x16x32_bf16 v[220:223], a[248:251], v[60:63], v[220:223]
    buffer_load_dwordx4 v242, s[20:23], s65 offen offset:2048 lds
    v_mfma_f32_16x16x32_bf16 v[220:223], a[252:255], v[64:67], v[220:223]
    s_waitcnt lgkmcnt(7)
    ds_read_b64_tr_b16 v[126:127], v253 offset:6152
    v_mfma_f32_16x16x32_bf16 v[224:227], a[224:227], v[68:71], v[224:227]
    v_mfma_f32_16x16x32_bf16 v[224:227], a[228:231], v[72:75], v[224:227]
    s_nop 0
    ds_read_b128 v[52:55], v248 offset:2048
    v_mfma_f32_16x16x32_bf16 v[228:231], a[232:235], v[68:71], v[228:231]
    buffer_load_dwordx4 v243, s[20:23], s65 offen offset:3072 lds
    v_mfma_f32_16x16x32_bf16 v[228:231], a[236:239], v[72:75], v[228:231]
    s_nop 0
    ds_read_b128 v[56:59], v249 offset:2048
    v_mfma_f32_16x16x32_bf16 v[232:235], a[240:243], v[68:71], v[232:235]
    s_add_u32 m0, s64, 32768
    s_lshl_b32 s65, s77, 19
    v_mfma_f32_16x16x32_bf16 v[232:235], a[244:247], v[72:75], v[232:235]
    buffer_load_dwordx4 v244, s[24:27], s65 offen offset:0 lds
    v_mfma_f32_16x16x32_bf16 v[236:239], a[248:251], v[68:71], v[236:239]
    v_mfma_f32_16x16x32_bf16 v[236:239], a[252:255], v[72:75], v[236:239]
    s_waitcnt lgkmcnt(2)
    v_mfma_f32_16x16x32_bf16 v[128:131], v[96:99], v[44:47], v[128:131]
    v_mfma_f32_16x16x32_bf16 v[128:131], v[100:103], v[48:51], v[128:131]
    s_nop 0
    ds_read_b128 v[60:63], v248 offset:4096
    v_mfma_f32_16x16x32_bf16 v[132:135], v[104:107], v[44:47], v[132:135]
    buffer_load_dwordx4 v245, s[24:27], s65 offen offset:1024 lds
    v_mfma_f32_16x16x32_bf16 v[132:135], v[108:111], v[48:51], v[132:135]
    s_nop 0
    ds_read_b128 v[64:67], v249 offset:4096
    v_mfma_f32_16x16x32_bf16 v[136:139], v[112:115], v[44:47], v[136:139]
    v_mfma_f32_16x16x32_bf16 v[136:139], v[116:119], v[48:51], v[136:139]
    buffer_load_dwordx4 v246, s[24:27], s65 offen offset:2048 lds
    v_mfma_f32_16x16x32_bf16 v[140:143], v[120:123], v[44:47], v[140:143]
    v_mfma_f32_16x16x32_bf16 v[140:143], v[124:127], v[48:51], v[140:143]
    s_waitcnt lgkmcnt(2)
    v_mfma_f32_16x16x32_bf16 v[144:147], v[96:99], v[52:55], v[144:147]
    v_mfma_f32_16x16x32_bf16 v[144:147], v[100:103], v[56:59], v[144:147]
    s_nop 0
    ds_read_b128 v[68:71], v248 offset:6144
    v_mfma_f32_16x16x32_bf16 v[148:151], v[104:107], v[52:55], v[148:151]
    buffer_load_dwordx4 v247, s[24:27], s65 offen offset:3072 lds
    v_mfma_f32_16x16x32_bf16 v[148:151], v[108:111], v[56:59], v[148:151]
    s_nop 0
    ds_read_b128 v[72:75], v249 offset:6144
    v_mfma_f32_16x16x32_bf16 v[152:155], v[112:115], v[52:55], v[152:155]
    s_add_u32 m0, s64, 36864
    s_add_u32 s65, s65, 262144
    v_mfma_f32_16x16x32_bf16 v[152:155], v[116:119], v[56:59], v[152:155]
    buffer_load_dwordx4 v244, s[24:27], s65 offen offset:0 lds
    v_mfma_f32_16x16x32_bf16 v[156:159], v[120:123], v[52:55], v[156:159]
    v_mfma_f32_16x16x32_bf16 v[156:159], v[124:127], v[56:59], v[156:159]
    s_waitcnt lgkmcnt(2)
    v_mfma_f32_16x16x32_bf16 v[160:163], v[96:99], v[60:63], v[160:163]
    v_mfma_f32_16x16x32_bf16 v[160:163], v[100:103], v[64:67], v[160:163]
    s_nop 0
    ds_read_b128 v[44:47], v248 offset:8192
    v_mfma_f32_16x16x32_bf16 v[164:167], v[104:107], v[60:63], v[164:167]
    buffer_load_dwordx4 v245, s[24:27], s65 offen offset:1024 lds
    v_mfma_f32_16x16x32_bf16 v[164:167], v[108:111], v[64:67], v[164:167]
    s_nop 0
    ds_read_b128 v[48:51], v249 offset:8192
    v_mfma_f32_16x16x32_bf16 v[168:171], v[112:115], v[60:63], v[168:171]
    v_mfma_f32_16x16x32_bf16 v[168:171], v[116:119], v[64:67], v[168:171]
    buffer_load_dwordx4 v246, s[24:27], s65 offen offset:2048 lds
    v_mfma_f32_16x16x32_bf16 v[172:175], v[120:123], v[60:63], v[172:175]
    v_mfma_f32_16x16x32_bf16 v[172:175], v[124:127], v[64:67], v[172:175]
    s_waitcnt lgkmcnt(2)
    v_mfma_f32_16x16x32_bf16 v[176:179], v[96:99], v[68:71], v[176:179]
    v_mfma_f32_16x16x32_bf16 v[176:179], v[100:103], v[72:75], v[176:179]
    s_waitcnt vmcnt(19)
    ds_read_b128 v[52:55], v248 offset:10240
    v_mfma_f32_16x16x32_bf16 v[180:183], v[104:107], v[68:71], v[180:183]
    s_barrier
    s_waitcnt vmcnt(11)
    ds_read_b64_tr_b16 a[224:225], v250 offset:0
    v_mfma_f32_16x16x32_bf16 v[180:183], v[108:111], v[72:75], v[180:183]
    s_nop 0
    ds_read_b128 v[56:59], v249 offset:10240
    ds_read_b64_tr_b16 a[226:227], v250 offset:2048
    v_mfma_f32_16x16x32_bf16 v[184:187], v[112:115], v[68:71], v[184:187]
    buffer_load_dwordx4 v247, s[24:27], s65 offen offset:3072 lds
    v_mfma_f32_16x16x32_bf16 v[184:187], v[116:119], v[72:75], v[184:187]
    s_add_u32 m0, s64, 65536
    s_lshl_b32 s65, s78, 19
    ds_read_b64_tr_b16 a[228:229], v250 offset:4096
    v_mfma_f32_16x16x32_bf16 v[188:191], v[120:123], v[68:71], v[188:191]
    buffer_load_dwordx4 v244, s[24:27], s65 offen offset:0 lds
    v_mfma_f32_16x16x32_bf16 v[188:191], v[124:127], v[72:75], v[188:191]
    s_waitcnt lgkmcnt(5)
    ds_read_b64_tr_b16 a[230:231], v250 offset:6144
    v_mfma_f32_16x16x32_bf16 v[192:195], v[96:99], v[44:47], v[192:195]
    s_nop 0
    ds_read_b64_tr_b16 a[232:233], v250 offset:8
    v_mfma_f32_16x16x32_bf16 v[192:195], v[100:103], v[48:51], v[192:195]
    s_nop 0
    ds_read_b128 v[60:63], v248 offset:12288
    ds_read_b64_tr_b16 a[234:235], v250 offset:2056
    v_mfma_f32_16x16x32_bf16 v[196:199], v[104:107], v[44:47], v[196:199]
    buffer_load_dwordx4 v245, s[24:27], s65 offen offset:1024 lds
    v_mfma_f32_16x16x32_bf16 v[196:199], v[108:111], v[48:51], v[196:199]
    s_nop 0
    ds_read_b128 v[64:67], v249 offset:12288
    ds_read_b64_tr_b16 a[236:237], v250 offset:4104
    v_mfma_f32_16x16x32_bf16 v[200:203], v[112:115], v[44:47], v[200:203]
    buffer_load_dwordx4 v246, s[24:27], s65 offen offset:2048 lds
    v_mfma_f32_16x16x32_bf16 v[200:203], v[116:119], v[48:51], v[200:203]
    s_nop 0
    ds_read_b64_tr_b16 a[238:239], v250 offset:6152
    v_mfma_f32_16x16x32_bf16 v[204:207], v[120:123], v[44:47], v[204:207]
    s_nop 0
    ds_read_b64_tr_b16 a[240:241], v251 offset:0
    v_mfma_f32_16x16x32_bf16 v[204:207], v[124:127], v[48:51], v[204:207]
    s_waitcnt lgkmcnt(7)
    ds_read_b64_tr_b16 a[242:243], v251 offset:2048
    v_mfma_f32_16x16x32_bf16 v[208:211], v[96:99], v[52:55], v[208:211]
    buffer_load_dwordx4 v247, s[24:27], s65 offen offset:3072 lds
    v_mfma_f32_16x16x32_bf16 v[208:211], v[100:103], v[56:59], v[208:211]
    s_nop 0
    ds_read_b128 v[68:71], v248 offset:16384
    ds_read_b64_tr_b16 a[244:245], v251 offset:4096
    v_mfma_f32_16x16x32_bf16 v[212:215], v[104:107], v[52:55], v[212:215]
    s_add_u32 m0, s64, 69632
    ds_read_b64_tr_b16 a[246:247], v251 offset:6144
    v_mfma_f32_16x16x32_bf16 v[212:215], v[108:111], v[56:59], v[212:215]
    s_add_u32 s65, s65, 262144
    ds_read_b128 v[72:75], v249 offset:16384
    ds_read_b64_tr_b16 a[248:249], v251 offset:8
    v_mfma_f32_16x16x32_bf16 v[216:219], v[112:115], v[52:55], v[216:219]
    buffer_load_dwordx4 v244, s[24:27], s65 offen offset:0 lds
    v_mfma_f32_16x16x32_bf16 v[216:219], v[116:119], v[56:59], v[216:219]
    s_nop 0
    ds_read_b64_tr_b16 a[250:251], v251 offset:2056
    v_mfma_f32_16x16x32_bf16 v[220:223], v[120:123], v[52:55], v[220:223]
    s_nop 0
    ds_read_b64_tr_b16 a[252:253], v251 offset:4104
    v_mfma_f32_16x16x32_bf16 v[220:223], v[124:127], v[56:59], v[220:223]
    s_waitcnt lgkmcnt(7)
    ds_read_b64_tr_b16 a[254:255], v251 offset:6152
    v_mfma_f32_16x16x32_bf16 v[224:227], v[96:99], v[60:63], v[224:227]
    buffer_load_dwordx4 v245, s[24:27], s65 offen offset:1024 lds
    v_mfma_f32_16x16x32_bf16 v[224:227], v[100:103], v[64:67], v[224:227]
    s_nop 0
    ds_read_b128 v[44:47], v248 offset:18432
    v_mfma_f32_16x16x32_bf16 v[228:231], v[104:107], v[60:63], v[228:231]
    v_mfma_f32_16x16x32_bf16 v[228:231], v[108:111], v[64:67], v[228:231]
    s_nop 0
    ds_read_b128 v[48:51], v249 offset:18432
    v_mfma_f32_16x16x32_bf16 v[232:235], v[112:115], v[60:63], v[232:235]
    buffer_load_dwordx4 v246, s[24:27], s65 offen offset:2048 lds
    v_mfma_f32_16x16x32_bf16 v[232:235], v[116:119], v[64:67], v[232:235]
    v_mfma_f32_16x16x32_bf16 v[236:239], v[120:123], v[60:63], v[236:239]
    v_mfma_f32_16x16x32_bf16 v[236:239], v[124:127], v[64:67], v[236:239]
    s_waitcnt lgkmcnt(2)
    v_mfma_f32_16x16x32_bf16 v[128:131], a[224:227], v[68:71], v[128:131]
    buffer_load_dwordx4 v247, s[24:27], s65 offen offset:3072 lds
    v_mfma_f32_16x16x32_bf16 v[128:131], a[228:231], v[72:75], v[128:131]
    s_lshl_b32 s63, s56, 12
    ds_read_b128 v[52:55], v248 offset:20480
    v_mfma_f32_16x16x32_bf16 v[132:135], a[232:235], v[68:71], v[132:135]
    s_waitcnt vmcnt(8)
    s_add_u32 m0, s63, 147456
    ds_read_b64_tr_b16 v[96:97], v250 offset:32768
    v_mfma_f32_16x16x32_bf16 v[132:135], a[236:239], v[72:75], v[132:135]
    s_lshl_b32 s65, s78, 7
    ds_read_b128 v[56:59], v249 offset:20480
    ds_read_b64_tr_b16 v[98:99], v250 offset:34816
    v_mfma_f32_16x16x32_bf16 v[136:139], a[240:243], v[68:71], v[136:139]
    buffer_load_dwordx4 v240, s[20:23], s65 offen offset:0 lds
    v_mfma_f32_16x16x32_bf16 v[136:139], a[244:247], v[72:75], v[136:139]
    s_nop 0
    ds_read_b64_tr_b16 v[100:101], v250 offset:36864
    v_mfma_f32_16x16x32_bf16 v[140:143], a[248:251], v[68:71], v[140:143]
    s_nop 0
    ds_read_b64_tr_b16 v[102:103], v250 offset:38912
    v_mfma_f32_16x16x32_bf16 v[140:143], a[252:255], v[72:75], v[140:143]
    s_waitcnt lgkmcnt(6)
    ds_read_b64_tr_b16 v[104:105], v250 offset:32776
    v_mfma_f32_16x16x32_bf16 v[144:147], a[224:227], v[44:47], v[144:147]
    buffer_load_dwordx4 v241, s[20:23], s65 offen offset:1024 lds
    v_mfma_f32_16x16x32_bf16 v[144:147], a[228:231], v[48:51], v[144:147]
    s_nop 0
    ds_read_b128 v[60:63], v248 offset:22528
    ds_read_b64_tr_b16 v[106:107], v250 offset:34824
    v_mfma_f32_16x16x32_bf16 v[148:151], a[232:235], v[44:47], v[148:151]
    s_nop 0
    ds_read_b64_tr_b16 v[108:109], v250 offset:36872
    v_mfma_f32_16x16x32_bf16 v[148:151], a[236:239], v[48:51], v[148:151]
    s_nop 0
    ds_read_b128 v[64:67], v249 offset:22528
    ds_read_b64_tr_b16 v[110:111], v250 offset:38920
    v_mfma_f32_16x16x32_bf16 v[152:155], a[240:243], v[44:47], v[152:155]
    buffer_load_dwordx4 v242, s[20:23], s65 offen offset:2048 lds
    v_mfma_f32_16x16x32_bf16 v[152:155], a[244:247], v[48:51], v[152:155]
    s_nop 0
    ds_read_b64_tr_b16 v[112:113], v251 offset:32768
    v_mfma_f32_16x16x32_bf16 v[156:159], a[248:251], v[44:47], v[156:159]
    s_nop 0
    ds_read_b64_tr_b16 v[114:115], v251 offset:34816
    v_mfma_f32_16x16x32_bf16 v[156:159], a[252:255], v[48:51], v[156:159]
    s_waitcnt lgkmcnt(7)
    ds_read_b64_tr_b16 v[116:117], v251 offset:36864
    v_mfma_f32_16x16x32_bf16 v[160:163], a[224:227], v[52:55], v[160:163]
    buffer_load_dwordx4 v243, s[20:23], s65 offen offset:3072 lds
    v_mfma_f32_16x16x32_bf16 v[160:163], a[228:231], v[56:59], v[160:163]
    s_nop 0
    ds_read_b128 v[68:71], v248 offset:24576
    ds_read_b64_tr_b16 v[118:119], v251 offset:38912
    v_mfma_f32_16x16x32_bf16 v[164:167], a[232:235], v[52:55], v[164:167]
    s_add_u32 m0, s64, 0
    ds_read_b64_tr_b16 v[120:121], v251 offset:32776
    v_mfma_f32_16x16x32_bf16 v[164:167], a[236:239], v[56:59], v[164:167]
    s_mov_b32 s60, 0
    ds_read_b128 v[72:75], v249 offset:24576
    ds_read_b64_tr_b16 v[122:123], v251 offset:34824
    v_mfma_f32_16x16x32_bf16 v[168:171], a[240:243], v[52:55], v[168:171]
    buffer_load_dwordx4 v24, s[28:31], s60 offen offset:0 nt lds
    v_mfma_f32_16x16x32_bf16 v[168:171], a[244:247], v[56:59], v[168:171]
    s_nop 0
    ds_read_b64_tr_b16 v[124:125], v251 offset:36872
    v_mfma_f32_16x16x32_bf16 v[172:175], a[248:251], v[52:55], v[172:175]
    s_nop 0
    ds_read_b64_tr_b16 v[126:127], v251 offset:38920
    v_mfma_f32_16x16x32_bf16 v[172:175], a[252:255], v[56:59], v[172:175]
    s_waitcnt lgkmcnt(7)
    v_mfma_f32_16x16x32_bf16 v[176:179], a[224:227], v[60:63], v[176:179]
    v_mfma_f32_16x16x32_bf16 v[176:179], a[228:231], v[64:67], v[176:179]
    s_nop 0
    ds_read_b128 v[44:47], v248 offset:26624
    v_mfma_f32_16x16x32_bf16 v[180:183], a[232:235], v[60:63], v[180:183]
    s_waitcnt vmcnt(5)
    ds_read_b64_tr_b16 a[192:193], v252 offset:0
    v_mfma_f32_16x16x32_bf16 v[180:183], a[236:239], v[64:67], v[180:183]
    s_nop 0
    ds_read_b128 v[48:51], v249 offset:26624
    ds_read_b64_tr_b16 a[194:195], v252 offset:2048
    v_mfma_f32_16x16x32_bf16 v[184:187], a[240:243], v[60:63], v[184:187]
    buffer_load_dwordx4 v25, s[28:31], s60 offen offset:1024 nt lds
    v_mfma_f32_16x16x32_bf16 v[184:187], a[244:247], v[64:67], v[184:187]
    s_waitcnt lgkmcnt(4)
    ds_read_b64_tr_b16 a[196:197], v252 offset:4096
    v_mfma_f32_16x16x32_bf16 v[188:191], a[248:251], v[60:63], v[188:191]
    s_nop 0
    ds_read_b64_tr_b16 a[198:199], v252 offset:6144
    v_mfma_f32_16x16x32_bf16 v[188:191], a[252:255], v[64:67], v[188:191]
    s_nop 0
    ds_read_b64_tr_b16 a[200:201], v252 offset:8
    v_mfma_f32_16x16x32_bf16 v[192:195], a[224:227], v[68:71], v[192:195]
    s_nop 0
    ds_read_b64_tr_b16 a[202:203], v252 offset:2056
    v_mfma_f32_16x16x32_bf16 v[192:195], a[228:231], v[72:75], v[192:195]
    s_nop 0
    ds_read_b128 v[52:55], v248 offset:28672
    ds_read_b64_tr_b16 a[204:205], v252 offset:4104
    v_mfma_f32_16x16x32_bf16 v[196:199], a[232:235], v[68:71], v[196:199]
    s_nop 0
    ds_read_b64_tr_b16 a[206:207], v252 offset:6152
    v_mfma_f32_16x16x32_bf16 v[196:199], a[236:239], v[72:75], v[196:199]
    s_nop 0
    ds_read_b128 v[56:59], v249 offset:28672
    ds_read_b64_tr_b16 a[208:209], v253 offset:0
    v_mfma_f32_16x16x32_bf16 v[200:203], a[240:243], v[68:71], v[200:203]
    buffer_load_dwordx4 v26, s[28:31], s60 offen offset:2048 nt lds
    v_mfma_f32_16x16x32_bf16 v[200:203], a[244:247], v[72:75], v[200:203]
    s_nop 0
    ds_read_b64_tr_b16 a[210:211], v253 offset:2048
    v_mfma_f32_16x16x32_bf16 v[204:207], a[248:251], v[68:71], v[204:207]
    s_nop 0
    ds_read_b64_tr_b16 a[212:213], v253 offset:4096
    v_mfma_f32_16x16x32_bf16 v[204:207], a[252:255], v[72:75], v[204:207]
    s_waitcnt lgkmcnt(8)
    ds_read_b64_tr_b16 a[214:215], v253 offset:6144
    v_mfma_f32_16x16x32_bf16 v[208:211], a[224:227], v[44:47], v[208:211]
    s_nop 0
    ds_read_b64_tr_b16 a[216:217], v253 offset:8
    v_mfma_f32_16x16x32_bf16 v[208:211], a[228:231], v[48:51], v[208:211]
    s_nop 0
    ds_read_b64_tr_b16 a[218:219], v253 offset:2056
    v_mfma_f32_16x16x32_bf16 v[212:215], a[232:235], v[44:47], v[212:215]
    s_waitcnt vmcnt(3)
    ds_read_b64_tr_b16 a[220:221], v253 offset:4104
    v_mfma_f32_16x16x32_bf16 v[212:215], a[236:239], v[48:51], v[212:215]
    s_barrier
    ds_read_b64_tr_b16 a[222:223], v253 offset:6152
    v_mfma_f32_16x16x32_bf16 v[216:219], a[240:243], v[44:47], v[216:219]
    s_nop 0
    ds_read_b128 v[76:79], v248 offset:32768
    v_mfma_f32_16x16x32_bf16 v[216:219], a[244:247], v[48:51], v[216:219]
    s_nop 0
    ds_read_b128 v[80:83], v249 offset:32768
    v_mfma_f32_16x16x32_bf16 v[220:223], a[248:251], v[44:47], v[220:223]
    s_nop 0
    ds_read_b128 v[84:87], v248 offset:49152
    v_mfma_f32_16x16x32_bf16 v[220:223], a[252:255], v[48:51], v[220:223]
    s_waitcnt lgkmcnt(7)
    ds_read_b128 v[88:91], v249 offset:49152
    v_mfma_f32_16x16x32_bf16 v[224:227], a[224:227], v[52:55], v[224:227]
    buffer_load_dwordx4 v27, s[28:31], s60 offen offset:3072 nt lds
    v_mfma_f32_16x16x32_bf16 v[224:227], a[228:231], v[56:59], v[224:227]
    s_nop 0
    ds_read_b128 v[60:63], v248 offset:34816
    v_mfma_f32_16x16x32_bf16 v[228:231], a[232:235], v[52:55], v[228:231]
    s_nop 0
    ds_read_b128 v[64:67], v249 offset:34816
    v_mfma_f32_16x16x32_bf16 v[228:231], a[236:239], v[56:59], v[228:231]
    s_nop 0
    ds_read_b128 v[68:71], v248 offset:51200
    v_mfma_f32_16x16x32_bf16 v[232:235], a[240:243], v[52:55], v[232:235]
    s_add_u32 m0, s64, 4096
    s_add_u32 s60, s60, 16384
    ds_read_b128 v[72:75], v249 offset:51200
    v_mfma_f32_16x16x32_bf16 v[232:235], a[244:247], v[56:59], v[232:235]
    buffer_load_dwordx4 v28, s[28:31], s60 offen offset:0 nt lds
    v_mfma_f32_16x16x32_bf16 v[236:239], a[248:251], v[52:55], v[236:239]
    v_mfma_f32_16x16x32_bf16 v[236:239], a[252:255], v[56:59], v[236:239]
    s_waitcnt lgkmcnt(4)
    v_mfma_f32_16x16x32_bf16 v[128:131], v[96:99], v[76:79], v[128:131]
    v_mfma_f32_16x16x32_bf16 v[128:131], v[100:103], v[80:83], v[128:131]
    v_mfma_f32_16x16x32_bf16 v[128:131], a[192:195], v[84:87], v[128:131]
    v_mfma_f32_16x16x32_bf16 v[128:131], a[196:199], v[88:91], v[128:131]
    ds_write_b64 v34, v[32:33]
    v_mfma_f32_16x16x32_bf16 v[132:135], v[104:107], v[76:79], v[132:135]
    buffer_load_dwordx4 v29, s[28:31], s60 offen offset:1024 nt lds
    v_mfma_f32_16x16x32_bf16 v[132:135], v[108:111], v[80:83], v[132:135]
    v_mfma_f32_16x16x32_bf16 v[132:135], a[200:203], v[84:87], v[132:135]
    v_cvt_pk_bf16_f32 v128, v128, v129
    v_cvt_pk_bf16_f32 v129, v130, v131
    v_mfma_f32_16x16x32_bf16 v[132:135], a[204:207], v[88:91], v[132:135]
    v_mfma_f32_16x16x32_bf16 v[136:139], v[112:115], v[76:79], v[136:139]
    s_barrier
    v_mfma_f32_16x16x32_bf16 v[136:139], v[116:119], v[80:83], v[136:139]
    v_mfma_f32_16x16x32_bf16 v[136:139], a[208:211], v[84:87], v[136:139]
    v_cvt_pk_bf16_f32 v130, v132, v133
    v_cvt_pk_bf16_f32 v131, v134, v135
    v_mfma_f32_16x16x32_bf16 v[136:139], a[212:215], v[88:91], v[136:139]
    v_mfma_f32_16x16x32_bf16 v[140:143], v[120:123], v[76:79], v[140:143]
    v_mfma_f32_16x16x32_bf16 v[140:143], v[124:127], v[80:83], v[140:143]
    s_nop 0
    ds_read_b128 v[44:47], v248 offset:36864
    v_mfma_f32_16x16x32_bf16 v[140:143], a[216:219], v[84:87], v[140:143]
    s_nop 0
    ds_read_b128 v[48:51], v249 offset:36864
    v_cvt_pk_bf16_f32 v136, v136, v137
    v_mfma_f32_16x16x32_bf16 v[140:143], a[220:223], v[88:91], v[140:143]
    s_waitcnt lgkmcnt(2)
    ds_read_b128 v[52:55], v248 offset:53248
    v_cvt_pk_bf16_f32 v137, v138, v139
    v_mfma_f32_16x16x32_bf16 v[144:147], v[96:99], v[60:63], v[144:147]
    s_nop 0
    ds_read_b128 v[56:59], v249 offset:53248
    v_mfma_f32_16x16x32_bf16 v[144:147], v[100:103], v[64:67], v[144:147]
    buffer_load_dwordx4 v30, s[28:31], s60 offen offset:2048 nt lds
    v_mfma_f32_16x16x32_bf16 v[144:147], a[192:195], v[68:71], v[144:147]
    v_cvt_pk_bf16_f32 v138, v140, v141
    v_cvt_pk_bf16_f32 v139, v142, v143
    v_mfma_f32_16x16x32_bf16 v[144:147], a[196:199], v[72:75], v[144:147]
    ds_write_b128 v254, v[128:131] offset:0
    v_mfma_f32_16x16x32_bf16 v[148:151], v[104:107], v[60:63], v[148:151]
    ds_write_b128 v254, v[136:139] offset:1024
    v_mfma_f32_16x16x32_bf16 v[148:151], v[108:111], v[64:67], v[148:151]
    buffer_load_dwordx4 v31, s[28:31], s60 offen offset:3072 nt lds
    v_mfma_f32_16x16x32_bf16 v[148:151], a[200:203], v[68:71], v[148:151]
    v_cvt_pk_bf16_f32 v144, v144, v145
    v_cvt_pk_bf16_f32 v145, v146, v147
    v_mfma_f32_16x16x32_bf16 v[148:151], a[204:207], v[72:75], v[148:151]
    v_mfma_f32_16x16x32_bf16 v[152:155], v[112:115], v[60:63], v[152:155]
    v_mfma_f32_16x16x32_bf16 v[152:155], v[116:119], v[64:67], v[152:155]
    v_mfma_f32_16x16x32_bf16 v[152:155], a[208:211], v[68:71], v[152:155]
    v_cvt_pk_bf16_f32 v146, v148, v149
    v_cvt_pk_bf16_f32 v147, v150, v151
    v_mfma_f32_16x16x32_bf16 v[152:155], a[212:215], v[72:75], v[152:155]
    v_mfma_f32_16x16x32_bf16 v[156:159], v[120:123], v[60:63], v[156:159]
    v_mfma_f32_16x16x32_bf16 v[156:159], v[124:127], v[64:67], v[156:159]
    s_nop 0
    ds_read_b128 v[76:79], v248 offset:38912
    v_mfma_f32_16x16x32_bf16 v[156:159], a[216:219], v[68:71], v[156:159]
    s_nop 0
    ds_read_b128 v[80:83], v249 offset:38912
    v_cvt_pk_bf16_f32 v152, v152, v153
    v_mfma_f32_16x16x32_bf16 v[156:159], a[220:223], v[72:75], v[156:159]
    s_waitcnt lgkmcnt(2)
    ds_read_b128 v[84:87], v248 offset:55296
    v_cvt_pk_bf16_f32 v153, v154, v155
    v_mfma_f32_16x16x32_bf16 v[160:163], v[96:99], v[44:47], v[160:163]
    s_add_u32 m0, s64, 32768
    s_add_u32 s60, s60, 16384
    ds_read_b128 v[88:91], v249 offset:55296
    v_mfma_f32_16x16x32_bf16 v[160:163], v[100:103], v[48:51], v[160:163]
    buffer_load_dwordx4 v24, s[28:31], s60 offen offset:0 nt lds
    v_mfma_f32_16x16x32_bf16 v[160:163], a[192:195], v[52:55], v[160:163]
    v_cvt_pk_bf16_f32 v154, v156, v157
    v_cvt_pk_bf16_f32 v155, v158, v159
    v_mfma_f32_16x16x32_bf16 v[160:163], a[196:199], v[56:59], v[160:163]
    ds_write_b128 v254, v[144:147] offset:8192
    v_mfma_f32_16x16x32_bf16 v[164:167], v[104:107], v[44:47], v[164:167]
    ds_write_b128 v254, v[152:155] offset:9216
    v_mfma_f32_16x16x32_bf16 v[164:167], v[108:111], v[48:51], v[164:167]
    buffer_load_dwordx4 v25, s[28:31], s60 offen offset:1024 nt lds
    v_mfma_f32_16x16x32_bf16 v[164:167], a[200:203], v[52:55], v[164:167]
    v_cvt_pk_bf16_f32 v160, v160, v161
    v_cvt_pk_bf16_f32 v161, v162, v163
    v_mfma_f32_16x16x32_bf16 v[164:167], a[204:207], v[56:59], v[164:167]
    v_mfma_f32_16x16x32_bf16 v[168:171], v[112:115], v[44:47], v[168:171]
    v_mfma_f32_16x16x32_bf16 v[168:171], v[116:119], v[48:51], v[168:171]
    v_mfma_f32_16x16x32_bf16 v[168:171], a[208:211], v[52:55], v[168:171]
    v_cvt_pk_bf16_f32 v162, v164, v165
    v_cvt_pk_bf16_f32 v163, v166, v167
    v_mfma_f32_16x16x32_bf16 v[168:171], a[212:215], v[56:59], v[168:171]
    v_mfma_f32_16x16x32_bf16 v[172:175], v[120:123], v[44:47], v[172:175]
    s_waitcnt lgkmcnt(0)
    v_mfma_f32_16x16x32_bf16 v[172:175], v[124:127], v[48:51], v[172:175]
    s_barrier
    ds_read_b128 v[60:63], v248 offset:40960
    v_mfma_f32_16x16x32_bf16 v[172:175], a[216:219], v[52:55], v[172:175]
    s_nop 0
    ds_read_b128 v[64:67], v249 offset:40960
    v_cvt_pk_bf16_f32 v168, v168, v169
    v_mfma_f32_16x16x32_bf16 v[172:175], a[220:223], v[56:59], v[172:175]
    s_nop 0
    ds_read_b128 v[68:71], v248 offset:57344
    v_cvt_pk_bf16_f32 v169, v170, v171
    v_mfma_f32_16x16x32_bf16 v[176:179], v[96:99], v[76:79], v[176:179]
    s_nop 0
    ds_read_b128 v[72:75], v249 offset:57344
    v_mfma_f32_16x16x32_bf16 v[176:179], v[100:103], v[80:83], v[176:179]
    s_nop 0
    ds_read_b128 a[0:3], v255 offset:0
    v_mfma_f32_16x16x32_bf16 v[176:179], a[192:195], v[84:87], v[176:179]
    v_cvt_pk_bf16_f32 v170, v172, v173
    v_cvt_pk_bf16_f32 v171, v174, v175
    v_mfma_f32_16x16x32_bf16 v[176:179], a[196:199], v[88:91], v[176:179]
    ds_write_b128 v254, v[160:163] offset:16384
    v_mfma_f32_16x16x32_bf16 v[180:183], v[104:107], v[76:79], v[180:183]
    ds_write_b128 v254, v[168:171] offset:17408
    v_mfma_f32_16x16x32_bf16 v[180:183], v[108:111], v[80:83], v[180:183]
    buffer_load_dwordx4 v26, s[28:31], s60 offen offset:2048 nt lds
    v_mfma_f32_16x16x32_bf16 v[180:183], a[200:203], v[84:87], v[180:183]
    v_cvt_pk_bf16_f32 v176, v176, v177
    v_cvt_pk_bf16_f32 v177, v178, v179
    v_mfma_f32_16x16x32_bf16 v[180:183], a[204:207], v[88:91], v[180:183]
    buffer_load_dwordx4 v27, s[28:31], s60 offen offset:3072 nt lds
    v_mfma_f32_16x16x32_bf16 v[184:187], v[112:115], v[76:79], v[184:187]
    v_mfma_f32_16x16x32_bf16 v[184:187], v[116:119], v[80:83], v[184:187]
    s_nop 0
    ds_read_b128 a[4:7], v255 offset:1024
    v_mfma_f32_16x16x32_bf16 v[184:187], a[208:211], v[84:87], v[184:187]
    s_nop 0
    ds_read_b128 a[8:11], v255 offset:2048
    v_cvt_pk_bf16_f32 v178, v180, v181
    v_mfma_f32_16x16x32_bf16 v[184:187], a[212:215], v[88:91], v[184:187]
    s_nop 0
    ds_read_b128 a[12:15], v255 offset:3072
    v_cvt_pk_bf16_f32 v179, v182, v183
    v_mfma_f32_16x16x32_bf16 v[188:191], v[120:123], v[76:79], v[188:191]
    s_nop 0
    ds_read_b128 a[16:19], v255 offset:4096
    v_mfma_f32_16x16x32_bf16 v[188:191], v[124:127], v[80:83], v[188:191]
    s_nop 0
    ds_read_b128 v[44:47], v248 offset:43008
    v_mfma_f32_16x16x32_bf16 v[188:191], a[216:219], v[84:87], v[188:191]
    s_nop 0
    ds_read_b128 v[48:51], v249 offset:43008
    v_cvt_pk_bf16_f32 v184, v184, v185
    v_mfma_f32_16x16x32_bf16 v[188:191], a[220:223], v[88:91], v[188:191]
    s_waitcnt lgkmcnt(6)
    ds_read_b128 v[52:55], v248 offset:59392
    v_cvt_pk_bf16_f32 v185, v186, v187
    v_mfma_f32_16x16x32_bf16 v[192:195], v[96:99], v[60:63], v[192:195]
    s_nop 0
    ds_read_b128 v[56:59], v249 offset:59392
    v_mfma_f32_16x16x32_bf16 v[192:195], v[100:103], v[64:67], v[192:195]
    s_nop 0
    ds_read_b128 a[20:23], v255 offset:5120
    v_mfma_f32_16x16x32_bf16 v[192:195], a[192:195], v[68:71], v[192:195]
    v_cvt_pk_bf16_f32 v186, v188, v189
    v_cvt_pk_bf16_f32 v187, v190, v191
    v_mfma_f32_16x16x32_bf16 v[192:195], a[196:199], v[72:75], v[192:195]
    s_add_u32 m0, s64, 36864
    ds_write_b128 v254, v[176:179] offset:24576
    v_mfma_f32_16x16x32_bf16 v[196:199], v[104:107], v[60:63], v[196:199]
    s_add_u32 s60, s60, 16384
    ds_write_b128 v254, v[184:187] offset:25600
    v_mfma_f32_16x16x32_bf16 v[196:199], v[108:111], v[64:67], v[196:199]
    buffer_load_dwordx4 v28, s[28:31], s60 offen offset:0 nt lds
    v_mfma_f32_16x16x32_bf16 v[196:199], a[200:203], v[68:71], v[196:199]
    v_cvt_pk_bf16_f32 v192, v192, v193
    v_cvt_pk_bf16_f32 v193, v194, v195
    v_mfma_f32_16x16x32_bf16 v[196:199], a[204:207], v[72:75], v[196:199]
    buffer_load_dwordx4 v29, s[28:31], s60 offen offset:1024 nt lds
    v_mfma_f32_16x16x32_bf16 v[200:203], v[112:115], v[60:63], v[200:203]
    v_mfma_f32_16x16x32_bf16 v[200:203], v[116:119], v[64:67], v[200:203]
    s_nop 0
    ds_read_b128 a[24:27], v255 offset:6144
    v_mfma_f32_16x16x32_bf16 v[200:203], a[208:211], v[68:71], v[200:203]
    s_nop 0
    ds_read_b128 a[28:31], v255 offset:7168
    v_cvt_pk_bf16_f32 v194, v196, v197
    v_mfma_f32_16x16x32_bf16 v[200:203], a[212:215], v[72:75], v[200:203]
    s_nop 0
    ds_read_b128 a[32:35], v255 offset:8192
    v_cvt_pk_bf16_f32 v195, v198, v199
    v_mfma_f32_16x16x32_bf16 v[204:207], v[120:123], v[60:63], v[204:207]
    s_nop 0
    ds_read_b128 a[36:39], v255 offset:9216
    v_mfma_f32_16x16x32_bf16 v[204:207], v[124:127], v[64:67], v[204:207]
    s_nop 0
    ds_read_b128 v[76:79], v248 offset:45056
    v_mfma_f32_16x16x32_bf16 v[204:207], a[216:219], v[68:71], v[204:207]
    s_nop 0
    ds_read_b128 v[80:83], v249 offset:45056
    v_cvt_pk_bf16_f32 v200, v200, v201
    v_mfma_f32_16x16x32_bf16 v[204:207], a[220:223], v[72:75], v[204:207]
    s_waitcnt lgkmcnt(6)
    ds_read_b128 v[84:87], v248 offset:61440
    v_cvt_pk_bf16_f32 v201, v202, v203
    v_mfma_f32_16x16x32_bf16 v[208:211], v[96:99], v[44:47], v[208:211]
    s_nop 0
    ds_read_b128 v[88:91], v249 offset:61440
    v_mfma_f32_16x16x32_bf16 v[208:211], v[100:103], v[48:51], v[208:211]
    s_nop 0
    ds_read_b128 a[40:43], v255 offset:10240
    v_mfma_f32_16x16x32_bf16 v[208:211], a[192:195], v[52:55], v[208:211]
    v_cvt_pk_bf16_f32 v202, v204, v205
    v_cvt_pk_bf16_f32 v203, v206, v207
    v_mfma_f32_16x16x32_bf16 v[208:211], a[196:199], v[56:59], v[208:211]
    ds_write_b128 v254, v[192:195] offset:32768
    v_mfma_f32_16x16x32_bf16 v[212:215], v[104:107], v[44:47], v[212:215]
    ds_write_b128 v254, v[200:203] offset:33792
    v_mfma_f32_16x16x32_bf16 v[212:215], v[108:111], v[48:51], v[212:215]
    buffer_load_dwordx4 v30, s[28:31], s60 offen offset:2048 nt lds
    v_mfma_f32_16x16x32_bf16 v[212:215], a[200:203], v[52:55], v[212:215]
    v_cvt_pk_bf16_f32 v208, v208, v209
    v_cvt_pk_bf16_f32 v209, v210, v211
    v_mfma_f32_16x16x32_bf16 v[212:215], a[204:207], v[56:59], v[212:215]
    buffer_load_dwordx4 v31, s[28:31], s60 offen offset:3072 nt lds
    v_mfma_f32_16x16x32_bf16 v[216:219], v[112:115], v[44:47], v[216:219]
    s_waitcnt vmcnt(8)
    v_mfma_f32_16x16x32_bf16 v[216:219], v[116:119], v[48:51], v[216:219]
    s_nop 0
    ds_read_b128 a[224:227], v16 offset:0
    v_mfma_f32_16x16x32_bf16 v[216:219], a[208:211], v[52:55], v[216:219]
    s_nop 0
    ds_read_b128 a[228:231], v17 offset:0
    v_cvt_pk_bf16_f32 v210, v212, v213
    v_mfma_f32_16x16x32_bf16 v[216:219], a[212:215], v[56:59], v[216:219]
    s_nop 0
    ds_read_b128 a[232:235], v18 offset:0
    v_cvt_pk_bf16_f32 v211, v214, v215
    v_mfma_f32_16x16x32_bf16 v[220:223], v[120:123], v[44:47], v[220:223]
    s_nop 0
    ds_read_b128 a[236:239], v19 offset:0
    v_mfma_f32_16x16x32_bf16 v[220:223], v[124:127], v[48:51], v[220:223]
    s_waitcnt lgkmcnt(4)
    ds_read_b128 a[240:243], v16 offset:256
    v_mfma_f32_16x16x32_bf16 v[220:223], a[216:219], v[52:55], v[220:223]
    s_barrier
    ds_read_b128 a[244:247], v17 offset:256
    v_cvt_pk_bf16_f32 v216, v216, v217
    v_mfma_f32_16x16x32_bf16 v[220:223], a[220:223], v[56:59], v[220:223]
    s_nop 0
    ds_read_b128 a[248:251], v18 offset:256
    v_cvt_pk_bf16_f32 v217, v218, v219
    v_mfma_f32_16x16x32_bf16 v[224:227], v[96:99], v[76:79], v[224:227]
    s_nop 0
    ds_read_b128 a[252:255], v19 offset:256
    v_mfma_f32_16x16x32_bf16 v[224:227], v[100:103], v[80:83], v[224:227]
    s_nop 0
    ds_read_b128 a[44:47], v255 offset:11264
    v_mfma_f32_16x16x32_bf16 v[224:227], a[192:195], v[84:87], v[224:227]
    v_cvt_pk_bf16_f32 v218, v220, v221
    v_cvt_pk_bf16_f32 v219, v222, v223
    v_mfma_f32_16x16x32_bf16 v[224:227], a[196:199], v[88:91], v[224:227]
    ds_write_b128 v254, v[208:211] offset:40960
    v_mfma_f32_16x16x32_bf16 v[228:231], v[104:107], v[76:79], v[228:231]
    ds_write_b128 v254, v[216:219] offset:41984
    v_mfma_f32_16x16x32_bf16 v[228:231], v[108:111], v[80:83], v[228:231]
    s_add_u32 m0, s64, 0
    v_mfma_f32_16x16x32_bf16 v[228:231], a[200:203], v[84:87], v[228:231]
    s_mov_b32 s61, 0
    v_cvt_pk_bf16_f32 v224, v224, v225
    v_cvt_pk_bf16_f32 v225, v226, v227
    v_mfma_f32_16x16x32_bf16 v[228:231], a[204:207], v[88:91], v[228:231]
    s_waitcnt lgkmcnt(3)
    v_mov_b32 v208, 0
    v_mov_b32 v209, 0
    v_mfma_f32_16x16x32_bf16 v[232:235], v[112:115], v[76:79], v[232:235]
    buffer_load_dwordx4 v20, s[32:35], s61 offen offset:0 nt lds
    v_mfma_f32_16x16x32_bf16 v[232:235], v[116:119], v[80:83], v[232:235]
    s_nop 0
    ds_read_b128 a[48:51], v255 offset:12288
    v_mov_b32 v210, 0
    v_mfma_f32_16x16x32_bf16 v[232:235], a[208:211], v[84:87], v[232:235]
    s_nop 0
    ds_read_b128 a[52:55], v255 offset:13312
    v_cvt_pk_bf16_f32 v226, v228, v229
    v_mfma_f32_16x16x32_bf16 v[232:235], a[212:215], v[88:91], v[232:235]
    s_nop 0
    ds_read_b128 a[56:59], v255 offset:14336
    v_cvt_pk_bf16_f32 v227, v230, v231
    v_mfma_f32_16x16x32_bf16 v[236:239], v[120:123], v[76:79], v[236:239]
    s_nop 0
    ds_read_b128 a[60:63], v255 offset:15360
    v_mov_b32 v211, 0
    v_mfma_f32_16x16x32_bf16 v[236:239], v[124:127], v[80:83], v[236:239]
    s_nop 0
    ds_read_b128 a[64:67], v255 offset:16384
    v_mov_b32 v212, 0
    v_mfma_f32_16x16x32_bf16 v[236:239], a[216:219], v[84:87], v[236:239]
    s_nop 0
    ds_read_b128 a[68:71], v255 offset:17408
    v_cvt_pk_bf16_f32 v232, v232, v233
    v_mfma_f32_16x16x32_bf16 v[236:239], a[220:223], v[88:91], v[236:239]
    s_nop 0
    ds_read_b128 a[72:75], v255 offset:18432
    v_cvt_pk_bf16_f32 v233, v234, v235
    v_mfma_f32_16x16x32_bf16 v[68:71], a[224:227], a[0:3], 0
    s_nop 0
    ds_read_b128 a[76:79], v255 offset:19456
    v_mov_b32 v213, 0
    v_mfma_f32_16x16x32_bf16 v[68:71], a[228:231], a[4:7], v[68:71]
    s_nop 0
    ds_read_b128 a[80:83], v255 offset:20480
    v_mov_b32 v214, 0
    v_mfma_f32_16x16x32_bf16 v[68:71], a[232:235], a[8:11], v[68:71]
    v_cvt_pk_bf16_f32 v234, v236, v237
    v_cvt_pk_bf16_f32 v235, v238, v239
    v_mfma_f32_16x16x32_bf16 v[68:71], a[236:239], a[12:15], v[68:71]
    ds_write_b128 v254, v[224:227] offset:49152
    v_mfma_f32_16x16x32_bf16 v[68:71], a[240:243], a[16:19], v[68:71]
    ds_write_b128 v254, v[232:235] offset:50176
    v_mfma_f32_16x16x32_bf16 v[68:71], a[244:247], a[20:23], v[68:71]
    buffer_load_dwordx4 v21, s[32:35], s61 offen offset:1024 nt lds
    v_mfma_f32_16x16x32_bf16 v[68:71], a[248:251], a[24:27], v[68:71]
    v_mov_b32 v215, 0
    v_mov_b32 v216, 0
    v_mfma_f32_16x16x32_bf16 v[68:71], a[252:255], a[28:31], v[68:71]
    v_mov_b32 v217, 0
    v_mov_b32 v218, 0
    v_mfma_f32_16x16x32_bf16 v[72:75], a[224:227], a[32:35], 0
    s_nop 0
    ds_read_b128 a[84:87], v255 offset:21504
    v_mov_b32 v219, 0
    v_mfma_f32_16x16x32_bf16 v[72:75], a[228:231], a[36:39], v[72:75]
    s_nop 0
    ds_read_b128 a[88:91], v255 offset:22528
    v_mov_b32 v220, 0
    v_mfma_f32_16x16x32_bf16 v[72:75], a[232:235], a[40:43], v[72:75]
    s_waitcnt lgkmcnt(4)
    ds_read_b128 a[92:95], v255 offset:23552
    v_max3_f32 v44, v68, v69, v70
    v_mfma_f32_16x16x32_bf16 v[72:75], a[236:239], a[44:47], v[72:75]
    s_nop 0
    ds_read_b128 a[96:99], v255 offset:24576
    v_max_f32 v44, v44, v71
    v_mfma_f32_16x16x32_bf16 v[72:75], a[240:243], a[48:51], v[72:75]
    s_nop 0
    ds_read_b128 a[100:103], v255 offset:25600
    v_mov_b32 v221, 0
    v_mfma_f32_16x16x32_bf16 v[72:75], a[244:247], a[52:55], v[72:75]
    s_waitcnt lgkmcnt(5)
    v_mov_b32 v222, 0
    v_mov_b32 v223, 0
    v_mfma_f32_16x16x32_bf16 v[72:75], a[248:251], a[56:59], v[72:75]
    s_barrier
    ds_read_b128 a[104:107], v255 offset:26624
    v_mov_b32 v224, 0
    v_mfma_f32_16x16x32_bf16 v[72:75], a[252:255], a[60:63], v[72:75]
    s_nop 0
    ds_read_b128 a[108:111], v255 offset:27648
    v_mov_b32 v225, 0
    v_mfma_f32_16x16x32_bf16 v[76:79], a[224:227], a[64:67], 0
    s_nop 0
    ds_read_b128 a[112:115], v255 offset:28672
    v_mov_b32 v226, 0
    v_mfma_f32_16x16x32_bf16 v[76:79], a[228:231], a[68:71], v[76:79]
    s_nop 0
    ds_read_b128 a[116:119], v255 offset:29696
    v_mov_b32 v227, 0
    v_mfma_f32_16x16x32_bf16 v[76:79], a[232:235], a[72:75], v[76:79]
    s_nop 0
    ds_read_b128 a[120:123], v255 offset:30720
    v_max3_f32 v45, v72, v73, v74
    v_mfma_f32_16x16x32_bf16 v[76:79], a[236:239], a[76:79], v[76:79]
    s_nop 0
    ds_read_b128 a[124:127], v255 offset:31744
    v_max_f32 v45, v45, v75
    v_mfma_f32_16x16x32_bf16 v[76:79], a[240:243], a[80:83], v[76:79]
    s_waitcnt lgkmcnt(6)
    ds_read_b128 a[128:131], v255 offset:32768
    v_mov_b32 v228, 0
    v_mfma_f32_16x16x32_bf16 v[76:79], a[244:247], a[84:87], v[76:79]
    s_nop 0
    ds_read_b128 a[132:135], v255 offset:33792
    v_mov_b32 v229, 0
    v_mfma_f32_16x16x32_bf16 v[76:79], a[248:251], a[88:91], v[76:79]
    buffer_load_dwordx4 v22, s[32:35], s61 offen offset:2048 nt lds
    v_mfma_f32_16x16x32_bf16 v[76:79], a[252:255], a[92:95], v[76:79]
    s_nop 0
    ds_read_b128 a[136:139], v255 offset:34816
    v_mov_b32 v230, 0
    v_mfma_f32_16x16x32_bf16 v[80:83], a[224:227], a[96:99], 0
    s_nop 0
    ds_read_b128 a[140:143], v255 offset:35840
    v_mov_b32 v231, 0
    v_mfma_f32_16x16x32_bf16 v[80:83], a[228:231], a[100:103], v[80:83]
    s_waitcnt lgkmcnt(6)
    ds_read_b128 a[144:147], v255 offset:36864
    v_add_u32 v232, 0x10000, v16
    v_mfma_f32_16x16x32_bf16 v[80:83], a[232:235], a[104:107], v[80:83]
    s_nop 0
    ds_read_b128 a[148:151], v255 offset:37888
    v_max3_f32 v46, v76, v77, v78
    v_mfma_f32_16x16x32_bf16 v[80:83], a[236:239], a[108:111], v[80:83]
    s_nop 0
    ds_read_b128 a[152:155], v255 offset:38912
    v_max_f32 v46, v46, v79
    v_mfma_f32_16x16x32_bf16 v[80:83], a[240:243], a[112:115], v[80:83]
    s_nop 0
    ds_read_b128 a[156:159], v255 offset:39936
    v_add_u32 v233, 0x10000, v17
    v_mfma_f32_16x16x32_bf16 v[80:83], a[244:247], a[116:119], v[80:83]
    s_waitcnt lgkmcnt(6)
    ds_read_b128 a[160:163], v255 offset:40960
    v_add_u32 v234, 0x10000, v18
    v_mfma_f32_16x16x32_bf16 v[80:83], a[248:251], a[120:123], v[80:83]
    s_nop 0
    ds_read_b128 a[164:167], v255 offset:41984
    v_add_u32 v235, 0x10000, v19
    v_mfma_f32_16x16x32_bf16 v[80:83], a[252:255], a[124:127], v[80:83]
    buffer_load_dwordx4 v23, s[32:35], s61 offen offset:3072 nt lds
    v_mfma_f32_16x16x32_bf16 v[84:87], a[224:227], a[128:131], 0
    s_nop 0
    ds_read_b128 a[168:171], v255 offset:43008
    v_mov_b32 v236, 0
    v_mfma_f32_16x16x32_bf16 v[84:87], a[228:231], a[132:135], v[84:87]
    s_waitcnt lgkmcnt(6)
    ds_read_b128 a[172:175], v255 offset:44032
    v_mov_b32 v237, 0
    v_mfma_f32_16x16x32_bf16 v[84:87], a[232:235], a[136:139], v[84:87]
    s_nop 0
    ds_read_b128 a[176:179], v255 offset:45056
    v_max3_f32 v47, v80, v81, v82
    v_mfma_f32_16x16x32_bf16 v[84:87], a[236:239], a[140:143], v[84:87]
    s_nop 0
    ds_read_b128 a[180:183], v255 offset:46080
    v_max_f32 v47, v47, v83
    v_mfma_f32_16x16x32_bf16 v[84:87], a[240:243], a[144:147], v[84:87]
    s_waitcnt lgkmcnt(6)
    ds_read_b128 a[184:187], v255 offset:47104
    v_mov_b32 v238, 0
    v_mfma_f32_16x16x32_bf16 v[84:87], a[244:247], a[148:151], v[84:87]
    s_waitcnt lgkmcnt(6)
    ds_read_b128 a[188:191], v255 offset:48128
    v_mov_b32 v239, 0
    v_mfma_f32_16x16x32_bf16 v[84:87], a[248:251], a[152:155], v[84:87]
    s_add_u32 m0, s64, 4096
    ds_read_b128 a[192:195], v255 offset:49152
    v_subrev_u32 v192, 0x10000, v12
    v_mfma_f32_16x16x32_bf16 v[84:87], a[252:255], a[156:159], v[84:87]
    s_add_u32 s61, s61, 16384
    ds_read_b128 a[196:199], v255 offset:50176
    v_subrev_u32 v193, 0x10000, v13
    v_mfma_f32_16x16x32_bf16 v[88:91], a[224:227], a[160:163], 0
    buffer_load_dwordx4 v20, s[32:35], s61 offen offset:0 nt lds
    s_waitcnt lgkmcnt(7)
    v_mfma_f32_16x16x32_bf16 v[88:91], a[228:231], a[164:167], v[88:91]
    s_nop 0
    ds_read_b128 a[200:203], v255 offset:51200
    v_subrev_u32 v194, 0x10000, v14
    v_mfma_f32_16x16x32_bf16 v[88:91], a[232:235], a[168:171], v[88:91]
    s_waitcnt lgkmcnt(6)
    ds_read_b128 a[204:207], v255 offset:52224
    v_max3_f32 v48, v84, v85, v86
    v_mfma_f32_16x16x32_bf16 v[88:91], a[236:239], a[172:175], v[88:91]
    s_nop 0
    ds_read_b128 a[208:211], v255 offset:53248
    v_max_f32 v48, v48, v87
    v_mfma_f32_16x16x32_bf16 v[88:91], a[240:243], a[176:179], v[88:91]
    s_waitcnt lgkmcnt(6)
    ds_read_b128 a[212:215], v255 offset:54272
    v_subrev_u32 v195, 0x10000, v15
    v_mfma_f32_16x16x32_bf16 v[88:91], a[244:247], a[180:183], v[88:91]
    s_nop 0
    ds_read_b128 a[216:219], v255 offset:55296
    v_lshl_add_u32 v60, v2, 6, v5
    v_mfma_f32_16x16x32_bf16 v[88:91], a[248:251], a[184:187], v[88:91]
    s_waitcnt lgkmcnt(6)
    ds_read_b128 a[220:223], v255 offset:56320
    v_mul_u32_u24 v60, 896, v60
    v_mfma_f32_16x16x32_bf16 v[88:91], a[252:255], a[188:191], v[88:91]
    buffer_load_dwordx4 v21, s[32:35], s61 offen offset:1024 nt lds
    v_mfma_f32_16x16x32_bf16 v[92:95], a[224:227], a[192:195], 0
    s_waitcnt lgkmcnt(5)
    ds_max_f32 v9, v44 offset:2048
    v_mfma_f32_16x16x32_bf16 v[92:95], a[228:231], a[196:199], v[92:95]
    buffer_load_dwordx4 v22, s[32:35], s61 offen offset:2048 nt lds
    v_mfma_f32_16x16x32_bf16 v[92:95], a[232:235], a[200:203], v[92:95]
    s_waitcnt lgkmcnt(4)
    v_max3_f32 v49, v88, v89, v90
    v_max_f32 v49, v49, v91
    v_mfma_f32_16x16x32_bf16 v[92:95], a[236:239], a[204:207], v[92:95]
    buffer_load_dwordx4 v23, s[32:35], s61 offen offset:3072 nt lds
    ds_max_f32 v9, v49 offset:2068
    v_mfma_f32_16x16x32_bf16 v[92:95], a[240:243], a[208:211], v[92:95]
    s_waitcnt lgkmcnt(4)
    ds_max_f32 v9, v45 offset:2052
    v_mfma_f32_16x16x32_bf16 v[92:95], a[244:247], a[212:215], v[92:95]
    s_waitcnt lgkmcnt(4)
    ds_max_f32 v9, v46 offset:2056
    v_mfma_f32_16x16x32_bf16 v[92:95], a[248:251], a[216:219], v[92:95]
    s_waitcnt lgkmcnt(4)
    ds_max_f32 v9, v47 offset:2060
    v_mfma_f32_16x16x32_bf16 v[92:95], a[252:255], a[220:223], v[92:95]
    ds_max_f32 v9, v48 offset:2064
    v_add_u32 v60, v60, v7
    v_mov_b32 v5, s79
    v_lshlrev_b32 v5, 2, v5
    v_add_u32 v61, 6144, v60
    v_add_u32 v62, 12288, v60
    v_add_u32 v63, 18432, v60
    v_mov_b32 v43, 1.0
    v_and_b32 v66, 1, v4
    v_lshl_add_u32 v66, v66, 4, v9
    v_lshrrev_b32 v67, 1, v4
    v_lshl_add_u32 v66, v67, 3, v66
    v_lshrrev_b32 v250, 2, v1
    v_lshlrev_b32 v250, 7, v250
    v_bfe_u32 v251, v1, 3, 2
    v_xor_b32 v251, v251, v2
    v_lshl_add_u32 v250, v251, 5, v250
    v_and_b32 v251, 3, v1
    v_lshl_add_u32 v250, v251, 3, v250
    v_add_u32 v251, 0x10000, v250
    v_lshl_add_u32 v253, v2, 9, v66
    v_lshlrev_b32 v248, 4, v0
    v_add_u32 v249, 155648, v8
    v_lshlrev_b32 v252, 5, v3
    v_add_u32 v255, 98304, v8
    v_lshl_add_u32 v254, v2, 11, v255
    s_nop 7
    v_max3_f32 v50, v92, v93, v94
    v_max_f32 v50, v50, v95
    ds_max_f32 v9, v50 offset:2072
    s_cmp_lg_u32 s66, 0
    s_cbranch_scc1 L_truemax
L_truemax_done:
    s_add_u32 m0, s64, 65536
    s_add_u32 s60, s60, 16384
    s_and_b32 s72, s79, 7
    s_lshl_b32 s72, s72, 2
    s_lshr_b32 s72, 0x53105310, s72
    s_and_b32 s72, s72, 15
    s_add_u32 s73, s72, 1
    s_cmp_eq_u32 s73, 7
    s_cselect_b32 s73, 0, s73
    s_add_u32 s74, s73, 1
    s_cmp_eq_u32 s74, 7
    s_cselect_b32 s74, 0, s74
    s_add_u32 s75, s74, 1
    s_cmp_eq_u32 s75, 7
    s_cselect_b32 s75, 0, s75
    s_waitcnt lgkmcnt(0)
    s_barrier
    ds_read_b128 v[44:47], v9 offset:2048
    ds_read_b128 v[48:51], v9 offset:2064
    s_waitcnt vmcnt(8)
    ds_read_b128 v[96:99], v16 offset:32768
    ds_read_b128 v[100:103], v17 offset:32768
    ds_read_b128 v[104:107], v18 offset:32768
    ds_read_b128 v[108:111], v19 offset:32768
    ds_read_b128 v[112:115], v16 offset:33024
    ds_read_b128 v[116:119], v17 offset:33024
    ds_read_b128 v[120:123], v18 offset:33024
    ds_read_b128 v[124:127], v19 offset:33024
    buffer_load_dwordx4 v24, s[28:31], s60 offen offset:0 nt lds
    buffer_load_dwordx4 v25, s[28:31], s60 offen offset:1024 nt lds
    s_add_u32 s76, s75, 1
    s_cmp_eq_u32 s76, 7
    s_cselect_b32 s76, 0, s76
    s_add_u32 s77, s76, 1
    s_cmp_eq_u32 s77, 7
    s_cselect_b32 s77, 0, s77
    s_add_u32 s78, s77, 1
    s_cmp_eq_u32 s78, 7
    s_cselect_b32 s78, 0, s78
    s_and_b32 s63, s58, 3
    s_lshr_b32 s65, s58, 2
    s_cmp_eq_u32 s63, s56
    s_cselect_b32 s71, s65, 5
    s_mov_b32 s69, 50343936
    s_getpc_b64 s[4:5]
L_pc1:
    s_add_u32 s4, s4, L_tail-L_pc1
    s_addc_u32 s5, s5, 0
    s_lshr_b32 s63, s2, 3
    s_lshl_b32 s63, s63, 10
    v_and_b32 v247, 1, v0
    v_lshlrev_b32 v247, 7, v247
    v_lshl_add_u32 v247, v2, 8, v247
    v_add_u32 v247, s63, v247
    v_subrev_u32 v52, L_end-L_tail, v247
    v_min_u32 v247, v247, v52
    v_min_u32 v247, L_last-L_tail, v247
    s_waitcnt lgkmcnt(9)
    v_mul_f32 v44, s3, v44
    v_mul_f32 v45, s3, v45
    v_mul_f32 v46, s3, v46
    v_mul_f32 v47, s3, v47
    s_waitcnt lgkmcnt(8)
    v_mul_f32 v48, s3, v48
    v_mul_f32 v49, s3, v49
    v_mul_f32 v50, s3, v50
    v_sub_f32 v240, 0, v44
    v_sub_f32 v241, 0, v45
    v_sub_f32 v242, 0, v46
    v_sub_f32 v243, 0, v47
    v_sub_f32 v244, 0, v48
    v_sub_f32 v245, 0, v49
    v_sub_f32 v246, 0, v50
    v_fma_f32 v68, v68, s3, v240
    v_fma_f32 v69, v69, s3, v240
    v_fma_f32 v70, v70, s3, v240
    v_fma_f32 v71, v71, s3, v240
    v_exp_f32 v68, v68
    v_exp_f32 v69, v69
    v_exp_f32 v70, v70
    v_exp_f32 v71, v71
    v_add_f32 v36, v68, v69
    v_cvt_pk_bf16_f32 v32, v68, v69
    v_cvt_pk_bf16_f32 v33, v70, v71
    v_add_f32 v36, v36, v70
    v_add_f32 v36, v36, v71
    ds_write_b64 v11, v[32:33] offset:0
    buffer_load_dwordx4 v26, s[28:31], s60 offen offset:2048 nt lds
    v_fma_f32 v72, v72, s3, v241
    v_fma_f32 v73, v73, s3, v241
    v_fma_f32 v74, v74, s3, v241
    v_fma_f32 v75, v75, s3, v241
    v_exp_f32 v72, v72
    v_exp_f32 v73, v73
    v_exp_f32 v74, v74
    v_exp_f32 v75, v75
    v_add_f32 v37, v72, v73
    v_cvt_pk_bf16_f32 v34, v72, v73
    v_cvt_pk_bf16_f32 v35, v74, v75
    v_add_f32 v37, v37, v74
    v_add_f32 v37, v37, v75
    ds_write_b64 v11, v[34:35] offset:2048
    buffer_load_dwordx4 v27, s[28:31], s60 offen offset:3072 nt lds
    v_fma_f32 v76, v76, s3, v242
    v_fma_f32 v77, v77, s3, v242
    v_fma_f32 v78, v78, s3, v242
    v_fma_f32 v79, v79, s3, v242
    v_exp_f32 v76, v76
    v_exp_f32 v77, v77
    v_exp_f32 v78, v78
    v_exp_f32 v79, v79
    v_add_f32 v38, v76, v77
    v_cvt_pk_bf16_f32 v32, v76, v77
    v_cvt_pk_bf16_f32 v33, v78, v79
    v_add_f32 v38, v38, v78
    v_add_f32 v38, v38, v79
    ds_write_b64 v11, v[32:33] offset:4096
    s_add_u32 m0, s64, 69632
    s_add_u32 s60, s60, 16384
    buffer_load_dwordx4 v28, s[28:31], s60 offen offset:0 nt lds
    v_fma_f32 v80, v80, s3, v243
    v_fma_f32 v81, v81, s3, v243
    v_fma_f32 v82, v82, s3, v243
    v_fma_f32 v83, v83, s3, v243
    v_exp_f32 v80, v80
    v_exp_f32 v81, v81
    v_exp_f32 v82, v82
    v_exp_f32 v83, v83
    v_add_f32 v39, v80, v81
    v_cvt_pk_bf16_f32 v34, v80, v81
    v_cvt_pk_bf16_f32 v35, v82, v83
    v_add_f32 v39, v39, v82
    v_add_f32 v39, v39, v83
    ds_write_b64 v11, v[34:35] offset:6144
    buffer_load_dwordx4 v29, s[28:31], s60 offen offset:1024 nt lds
    v_fma_f32 v84, v84, s3, v244
    v_fma_f32 v85, v85, s3, v244
    v_fma_f32 v86, v86, s3, v244
    v_fma_f32 v87, v87, s3, v244
    v_exp_f32 v84, v84
    v_exp_f32 v85, v85
    v_exp_f32 v86, v86
    v_exp_f32 v87, v87
    v_add_f32 v40, v84, v85
    v_cvt_pk_bf16_f32 v32, v84, v85
    v_cvt_pk_bf16_f32 v33, v86, v87
    v_add_f32 v40, v40, v86
    v_add_f32 v40, v40, v87
    ds_write_b64 v11, v[32:33] offset:8192
    buffer_load_dwordx4 v30, s[28:31], s60 offen offset:2048 nt lds
    v_fma_f32 v88, v88, s3, v245
    v_fma_f32 v89, v89, s3, v245
    v_fma_f32 v90, v90, s3, v245
    v_fma_f32 v91, v91, s3, v245
    v_exp_f32 v88, v88
    v_exp_f32 v89, v89
    v_exp_f32 v90, v90
    v_exp_f32 v91, v91
    v_add_f32 v41, v88, v89
    v_cvt_pk_bf16_f32 v34, v88, v89
    v_cvt_pk_bf16_f32 v35, v90, v91
    v_add_f32 v41, v41, v90
    v_add_f32 v41, v41, v91
    ds_write_b64 v11, v[34:35] offset:10240
    buffer_load_dwordx4 v31, s[28:31], s60 offen offset:3072 nt lds
    v_fma_f32 v92, v92, s3, v246
    v_fma_f32 v93, v93, s3, v246
    v_fma_f32 v94, v94, s3, v246
    v_fma_f32 v95, v95, s3, v246
    v_exp_f32 v92, v92
    v_exp_f32 v93, v93
    v_exp_f32 v94, v94
    v_exp_f32 v95, v95
    v_add_f32 v42, v92, v93
    v_cvt_pk_bf16_f32 v32, v92, v93
    v_cvt_pk_bf16_f32 v33, v94, v95
    v_add_f32 v42, v42, v94
    v_add_f32 v42, v42, v95
    ds_write_b64 v11, v[32:33] offset:12288
    s_waitcnt lgkmcnt(14)
    v_mfma_f32_16x16x32_bf16 v[68:71], v[96:99], a[0:3], 0
    s_waitcnt lgkmcnt(13)
    v_mfma_f32_16x16x32_bf16 v[68:71], v[100:103], a[4:7], v[68:71]
    s_waitcnt lgkmcnt(11)
    s_add_u32 m0, s64, 98304
    s_add_u32 s61, s61, 16384
    v_mfma_f32_16x16x32_bf16 v[68:71], v[104:107], a[8:11], v[68:71]
    buffer_load_dwordx4 v20, s[32:35], s61 offen offset:0 nt lds
    v_mfma_f32_16x16x32_bf16 v[68:71], v[108:111], a[12:15], v[68:71]
    s_waitcnt lgkmcnt(9)
    v_mfma_f32_16x16x32_bf16 v[68:71], v[112:115], a[16:19], v[68:71]
    buffer_load_dwordx4 v21, s[32:35], s61 offen offset:1024 nt lds
    v_mfma_f32_16x16x32_bf16 v[68:71], v[116:119], a[20:23], v[68:71]
    s_waitcnt lgkmcnt(8)
    v_mfma_f32_16x16x32_bf16 v[68:71], v[120:123], a[24:27], v[68:71]
    s_waitcnt lgkmcnt(0)
    v_mfma_f32_16x16x32_bf16 v[68:71], v[124:127], a[28:31], v[68:71]
    s_barrier
    v_mfma_f32_16x16x32_bf16 v[72:75], v[96:99], a[32:35], 0
    v_mfma_f32_16x16x32_bf16 v[72:75], v[100:103], a[36:39], v[72:75]
    s_nop 0
    ds_read_b128 v[52:55], v10 offset:0
    ds_read_b128 v[56:59], v10 offset:1024
    v_mfma_f32_16x16x32_bf16 v[72:75], v[104:107], a[40:43], v[72:75]
    buffer_load_dwordx4 v22, s[32:35], s61 offen offset:2048 nt lds
    v_mfma_f32_16x16x32_bf16 v[72:75], v[108:111], a[44:47], v[72:75]
    v_fma_f32 v68, v68, s3, v240
    v_fma_f32 v69, v69, s3, v240
    v_mfma_f32_16x16x32_bf16 v[72:75], v[112:115], a[48:51], v[72:75]
    v_fma_f32 v70, v70, s3, v240
    v_fma_f32 v71, v71, s3, v240
    v_mfma_f32_16x16x32_bf16 v[72:75], v[116:119], a[52:55], v[72:75]
    buffer_load_dwordx4 v23, s[32:35], s61 offen offset:3072 nt lds
    v_mfma_f32_16x16x32_bf16 v[72:75], v[120:123], a[56:59], v[72:75]
    v_exp_f32 v68, v68
    v_mfma_f32_16x16x32_bf16 v[72:75], v[124:127], a[60:63], v[72:75]
    v_exp_f32 v69, v69
    v_mfma_f32_16x16x32_bf16 v[76:79], v[96:99], a[64:67], 0
    s_waitcnt vmcnt(12)
    ds_read_b64_tr_b16 a[224:225], v192 offset:0
    ds_read_b64_tr_b16 a[226:227], v192 offset:512
    v_mfma_f32_16x16x32_bf16 v[76:79], v[100:103], a[68:71], v[76:79]
    s_nop 0
    ds_read_b64_tr_b16 a[228:229], v192 offset:1024
    ds_read_b64_tr_b16 a[230:231], v192 offset:1536
    v_mfma_f32_16x16x32_bf16 v[76:79], v[104:107], a[72:75], v[76:79]
    s_nop 0
    ds_read_b64_tr_b16 a[232:233], v193 offset:0
    ds_read_b64_tr_b16 a[234:235], v193 offset:512
    v_mfma_f32_16x16x32_bf16 v[76:79], v[108:111], a[76:79], v[76:79]
    s_nop 0
    ds_read_b64_tr_b16 a[236:237], v193 offset:1024
    ds_read_b64_tr_b16 a[238:239], v193 offset:1536
    v_mfma_f32_16x16x32_bf16 v[76:79], v[112:115], a[80:83], v[76:79]
    s_nop 0
    ds_read_b64_tr_b16 a[240:241], v194 offset:0
    ds_read_b64_tr_b16 a[242:243], v194 offset:512
    v_mfma_f32_16x16x32_bf16 v[76:79], v[116:119], a[84:87], v[76:79]
    s_nop 0
    ds_read_b64_tr_b16 a[244:245], v194 offset:1024
    ds_read_b64_tr_b16 a[246:247], v194 offset:1536
    v_mfma_f32_16x16x32_bf16 v[76:79], v[120:123], a[88:91], v[76:79]
    s_nop 0
    ds_read_b64_tr_b16 a[248:249], v195 offset:0
    ds_read_b64_tr_b16 a[250:251], v195 offset:512
    v_mfma_f32_16x16x32_bf16 v[76:79], v[124:127], a[92:95], v[76:79]
    s_waitcnt lgkmcnt(8)
    ds_read_b64_tr_b16 a[252:253], v195 offset:1024
    ds_read_b64_tr_b16 a[254:255], v195 offset:1536
    v_mfma_f32_16x16x32_bf16 v[128:131], a[224:227], v[52:55], 0
    s_add_u32 m0, s64, 102400
    v_exp_f32 v70, v70
    v_mfma_f32_16x16x32_bf16 v[128:131], a[228:231], v[56:59], v[128:131]
    s_add_u32 s61, s61, 16384
    ds_read_b128 v[44:47], v10 offset:2048
    ds_read_b128 v[48:51], v10 offset:3072
    v_mfma_f32_16x16x32_bf16 v[132:135], a[232:235], v[52:55], 0
    buffer_load_dwordx4 v20, s[32:35], s61 offen offset:0 nt lds
    s_waitcnt lgkmcnt(10)
    v_mfma_f32_16x16x32_bf16 v[132:135], a[236:239], v[56:59], v[132:135]
    s_waitcnt lgkmcnt(8)
    v_exp_f32 v71, v71
    v_mfma_f32_16x16x32_bf16 v[136:139], a[240:243], v[52:55], 0
    s_waitcnt lgkmcnt(6)
    v_cvt_pk_bf16_f32 v34, v68, v69
    v_cvt_pk_bf16_f32 v35, v70, v71
    v_mfma_f32_16x16x32_bf16 v[136:139], a[244:247], v[56:59], v[136:139]
    s_waitcnt lgkmcnt(4)
    ds_write_b64 v11, v[34:35] offset:14336
    v_mfma_f32_16x16x32_bf16 v[140:143], a[248:251], v[52:55], 0
    s_waitcnt lgkmcnt(3)
    v_add_f32 v36, v36, v68
    v_add_f32 v36, v36, v69
    v_mfma_f32_16x16x32_bf16 v[140:143], a[252:255], v[56:59], v[140:143]
    buffer_load_dwordx4 v21, s[32:35], s61 offen offset:1024 nt lds
    v_mfma_f32_16x16x32_bf16 v[80:83], v[96:99], a[96:99], 0
    v_add_f32 v36, v36, v70
    v_add_f32 v36, v36, v71
    v_mfma_f32_16x16x32_bf16 v[80:83], v[100:103], a[100:103], v[80:83]
    v_fma_f32 v72, v72, s3, v241
    v_fma_f32 v73, v73, s3, v241
    v_mfma_f32_16x16x32_bf16 v[80:83], v[104:107], a[104:107], v[80:83]
    v_fma_f32 v74, v74, s3, v241
    v_fma_f32 v75, v75, s3, v241
    v_mfma_f32_16x16x32_bf16 v[80:83], v[108:111], a[108:111], v[80:83]
    v_exp_f32 v72, v72
    v_mfma_f32_16x16x32_bf16 v[80:83], v[112:115], a[112:115], v[80:83]
    s_nop 0
    ds_read_b128 v[52:55], v10 offset:4096
    ds_read_b128 v[56:59], v10 offset:5120
    v_mfma_f32_16x16x32_bf16 v[80:83], v[116:119], a[116:119], v[80:83]
    buffer_load_dwordx4 v22, s[32:35], s61 offen offset:2048 nt lds
    v_mfma_f32_16x16x32_bf16 v[80:83], v[120:123], a[120:123], v[80:83]
    v_exp_f32 v73, v73
    v_mfma_f32_16x16x32_bf16 v[80:83], v[124:127], a[124:127], v[80:83]
    s_waitcnt lgkmcnt(2)
    v_exp_f32 v74, v74
    v_mfma_f32_16x16x32_bf16 v[144:147], a[224:227], v[44:47], 0
    v_exp_f32 v75, v75
    v_mfma_f32_16x16x32_bf16 v[144:147], a[228:231], v[48:51], v[144:147]
    v_cvt_pk_bf16_f32 v32, v72, v73
    v_cvt_pk_bf16_f32 v33, v74, v75
    v_mfma_f32_16x16x32_bf16 v[148:151], a[232:235], v[44:47], 0
    ds_write_b64 v11, v[32:33] offset:16384
    v_mfma_f32_16x16x32_bf16 v[148:151], a[236:239], v[48:51], v[148:151]
    buffer_load_dwordx4 v23, s[32:35], s61 offen offset:3072 nt lds
    v_mfma_f32_16x16x32_bf16 v[152:155], a[240:243], v[44:47], 0
    v_add_f32 v37, v37, v72
    v_add_f32 v37, v37, v73
    v_mfma_f32_16x16x32_bf16 v[152:155], a[244:247], v[48:51], v[152:155]
    v_add_f32 v37, v37, v74
    v_add_f32 v37, v37, v75
    v_mfma_f32_16x16x32_bf16 v[156:159], a[248:251], v[44:47], 0
    v_fma_f32 v76, v76, s3, v242
    v_fma_f32 v77, v77, s3, v242
    v_mfma_f32_16x16x32_bf16 v[156:159], a[252:255], v[48:51], v[156:159]
    s_add_u32 m0, s64, 32768
    v_fma_f32 v78, v78, s3, v242
    v_fma_f32 v79, v79, s3, v242
    v_mfma_f32_16x16x32_bf16 v[84:87], v[96:99], a[128:131], 0
    s_add_u32 s60, s60, 16384
    v_exp_f32 v76, v76
    v_mfma_f32_16x16x32_bf16 v[84:87], v[100:103], a[132:135], v[84:87]
    buffer_load_dwordx4 v24, s[28:31], s60 offen offset:0 nt lds
    v_mfma_f32_16x16x32_bf16 v[84:87], v[104:107], a[136:139], v[84:87]
    s_nop 0
    ds_read_b128 v[44:47], v10 offset:6144
    ds_read_b128 v[48:51], v10 offset:7168
    v_mfma_f32_16x16x32_bf16 v[84:87], v[108:111], a[140:143], v[84:87]
    v_exp_f32 v77, v77
    v_mfma_f32_16x16x32_bf16 v[84:87], v[112:115], a[144:147], v[84:87]
    v_exp_f32 v78, v78
    v_mfma_f32_16x16x32_bf16 v[84:87], v[116:119], a[148:151], v[84:87]
    v_exp_f32 v79, v79
    v_mfma_f32_16x16x32_bf16 v[84:87], v[120:123], a[152:155], v[84:87]
    buffer_load_dwordx4 v25, s[28:31], s60 offen offset:1024 nt lds
    v_mfma_f32_16x16x32_bf16 v[84:87], v[124:127], a[156:159], v[84:87]
    s_waitcnt lgkmcnt(2)
    v_cvt_pk_bf16_f32 v34, v76, v77
    v_cvt_pk_bf16_f32 v35, v78, v79
    v_mfma_f32_16x16x32_bf16 v[160:163], a[224:227], v[52:55], 0
    ds_write_b64 v11, v[34:35] offset:18432
    v_mfma_f32_16x16x32_bf16 v[160:163], a[228:231], v[56:59], v[160:163]
    v_add_f32 v38, v38, v76
    v_add_f32 v38, v38, v77
    v_mfma_f32_16x16x32_bf16 v[164:167], a[232:235], v[52:55], 0
    v_add_f32 v38, v38, v78
    v_add_f32 v38, v38, v79
    v_mfma_f32_16x16x32_bf16 v[164:167], a[236:239], v[56:59], v[164:167]
    buffer_load_dwordx4 v26, s[28:31], s60 offen offset:2048 nt lds
    v_mfma_f32_16x16x32_bf16 v[168:171], a[240:243], v[52:55], 0
    v_fma_f32 v80, v80, s3, v243
    v_fma_f32 v81, v81, s3, v243
    v_mfma_f32_16x16x32_bf16 v[168:171], a[244:247], v[56:59], v[168:171]
    v_fma_f32 v82, v82, s3, v243
    v_fma_f32 v83, v83, s3, v243
    v_mfma_f32_16x16x32_bf16 v[172:175], a[248:251], v[52:55], 0
    v_exp_f32 v80, v80
    v_mfma_f32_16x16x32_bf16 v[172:175], a[252:255], v[56:59], v[172:175]
    v_exp_f32 v81, v81
    v_mfma_f32_16x16x32_bf16 v[88:91], v[96:99], a[160:163], 0
    buffer_load_dwordx4 v27, s[28:31], s60 offen offset:3072 nt lds
    v_mfma_f32_16x16x32_bf16 v[88:91], v[100:103], a[164:167], v[88:91]
    v_exp_f32 v82, v82
    v_mfma_f32_16x16x32_bf16 v[88:91], v[104:107], a[168:171], v[88:91]
    s_nop 0
    ds_read_b128 v[52:55], v10 offset:8192
    ds_read_b128 v[56:59], v10 offset:9216
    v_mfma_f32_16x16x32_bf16 v[88:91], v[108:111], a[172:175], v[88:91]
    s_add_u32 m0, s64, 36864
    v_exp_f32 v83, v83
    v_mfma_f32_16x16x32_bf16 v[88:91], v[112:115], a[176:179], v[88:91]
    s_add_u32 s60, s60, 16384
    v_cvt_pk_bf16_f32 v32, v80, v81
    v_cvt_pk_bf16_f32 v33, v82, v83
    v_mfma_f32_16x16x32_bf16 v[88:91], v[116:119], a[180:183], v[88:91]
    buffer_load_dwordx4 v28, s[28:31], s60 offen offset:0 nt lds
    v_mfma_f32_16x16x32_bf16 v[88:91], v[120:123], a[184:187], v[88:91]
    ds_write_b64 v11, v[32:33] offset:20480
    v_mfma_f32_16x16x32_bf16 v[88:91], v[124:127], a[188:191], v[88:91]
    s_waitcnt lgkmcnt(3)
    v_add_f32 v39, v39, v80
    v_add_f32 v39, v39, v81
    v_mfma_f32_16x16x32_bf16 v[176:179], a[224:227], v[44:47], 0
    v_add_f32 v39, v39, v82
    v_add_f32 v39, v39, v83
    v_mfma_f32_16x16x32_bf16 v[176:179], a[228:231], v[48:51], v[176:179]
    v_fma_f32 v84, v84, s3, v244
    v_fma_f32 v85, v85, s3, v244
    v_mfma_f32_16x16x32_bf16 v[180:183], a[232:235], v[44:47], 0
    buffer_load_dwordx4 v29, s[28:31], s60 offen offset:1024 nt lds
    v_mfma_f32_16x16x32_bf16 v[180:183], a[236:239], v[48:51], v[180:183]
    v_fma_f32 v86, v86, s3, v244
    v_fma_f32 v87, v87, s3, v244
    v_mfma_f32_16x16x32_bf16 v[184:187], a[240:243], v[44:47], 0
    v_exp_f32 v84, v84
    v_mfma_f32_16x16x32_bf16 v[184:187], a[244:247], v[48:51], v[184:187]
    v_exp_f32 v85, v85
    v_mfma_f32_16x16x32_bf16 v[188:191], a[248:251], v[44:47], 0
    buffer_load_dwordx4 v30, s[28:31], s60 offen offset:2048 nt lds
    v_mfma_f32_16x16x32_bf16 v[188:191], a[252:255], v[48:51], v[188:191]
    v_exp_f32 v86, v86
    v_exp_f32 v87, v87
    v_mfma_f32_16x16x32_bf16 v[92:95], v[96:99], a[192:195], 0
    s_waitcnt vmcnt(15)
    ds_read_b128 v[44:47], v10 offset:10240
    ds_read_b128 v[48:51], v10 offset:11264
    v_mfma_f32_16x16x32_bf16 v[92:95], v[100:103], a[196:199], v[92:95]
    s_nop 0
    ds_read_b128 v[96:99], v232 offset:0
    v_cvt_pk_bf16_f32 v34, v84, v85
    v_cvt_pk_bf16_f32 v35, v86, v87
    v_mfma_f32_16x16x32_bf16 v[92:95], v[104:107], a[200:203], v[92:95]
    s_nop 0
    ds_read_b128 v[100:103], v233 offset:0
    ds_write_b64 v11, v[34:35] offset:22528
    v_mfma_f32_16x16x32_bf16 v[92:95], v[108:111], a[204:207], v[92:95]
    s_nop 0
    ds_read_b128 v[104:107], v234 offset:0
    v_add_f32 v40, v40, v84
    v_mfma_f32_16x16x32_bf16 v[92:95], v[112:115], a[208:211], v[92:95]
    s_nop 0
    ds_read_b128 v[108:111], v235 offset:0
    v_add_f32 v40, v40, v85
    v_mfma_f32_16x16x32_bf16 v[92:95], v[116:119], a[212:215], v[92:95]
    s_nop 0
    ds_read_b128 v[112:115], v232 offset:256
    v_add_f32 v40, v40, v86
    v_mfma_f32_16x16x32_bf16 v[92:95], v[120:123], a[216:219], v[92:95]
    s_nop 0
    ds_read_b128 v[116:119], v233 offset:256
    v_add_f32 v40, v40, v87
    v_mfma_f32_16x16x32_bf16 v[92:95], v[124:127], a[220:223], v[92:95]
    s_waitcnt lgkmcnt(9)
    ds_read_b128 v[120:123], v234 offset:256
    v_fma_f32 v88, v88, s3, v245
    v_fma_f32 v89, v89, s3, v245
    v_fma_f32 v90, v90, s3, v245
    v_fma_f32 v91, v91, s3, v245
    v_mfma_f32_16x16x32_bf16 v[192:195], a[224:227], v[52:55], 0
    s_nop 0
    ds_read_b128 v[124:127], v235 offset:256
    v_exp_f32 v88, v88
    v_exp_f32 v89, v89
    v_exp_f32 v90, v90
    v_exp_f32 v91, v91
    v_mfma_f32_16x16x32_bf16 v[192:195], a[228:231], v[56:59], v[192:195]
    v_mov_b32 v232, 0
    v_mov_b32 v233, 0
    v_mov_b32 v234, 0
    v_mov_b32 v235, 0
    v_cvt_pk_bf16_f32 v32, v88, v89
    v_cvt_pk_bf16_f32 v33, v90, v91
    v_add_f32 v41, v41, v88
    v_add_f32 v41, v41, v89
    v_add_f32 v41, v41, v90
    v_add_f32 v41, v41, v91
    v_mfma_f32_16x16x32_bf16 v[196:199], a[232:235], v[52:55], 0
    ds_write_b64 v11, v[32:33] offset:24576
    v_fma_f32 v92, v92, s3, v246
    v_fma_f32 v93, v93, s3, v246
    v_mfma_f32_16x16x32_bf16 v[196:199], a[236:239], v[56:59], v[196:199]
    v_fma_f32 v94, v94, s3, v246
    v_fma_f32 v95, v95, s3, v246
    v_mfma_f32_16x16x32_bf16 v[200:203], a[240:243], v[52:55], 0
    buffer_load_dwordx4 v31, s[28:31], s60 offen offset:3072 nt lds
    v_mfma_f32_16x16x32_bf16 v[200:203], a[244:247], v[56:59], v[200:203]
    v_exp_f32 v92, v92
    v_mfma_f32_16x16x32_bf16 v[204:207], a[248:251], v[52:55], 0
    v_exp_f32 v93, v93
    v_mfma_f32_16x16x32_bf16 v[204:207], a[252:255], v[56:59], v[204:207]
    s_waitcnt lgkmcnt(1)
    v_exp_f32 v94, v94
    s_mov_b32 s62, 6
    .p2align 6
L_loop:
    v_mfma_f32_16x16x32_bf16 v[68:71], v[96:99], a[0:3], 0
    v_exp_f32 v95, v95
    v_mfma_f32_16x16x32_bf16 v[68:71], v[100:103], a[4:7], v[68:71]
    v_cvt_pk_bf16_f32 v34, v92, v93
    v_cvt_pk_bf16_f32 v35, v94, v95
    v_mfma_f32_16x16x32_bf16 v[68:71], v[104:107], a[8:11], v[68:71]
    s_nop 0
    ds_read_b128 v[52:55], v10 offset:12288
    ds_read_b128 v[56:59], v10 offset:13312
    v_mfma_f32_16x16x32_bf16 v[68:71], v[108:111], a[12:15], v[68:71]
    s_add_u32 m0, s64, 65536
    ds_write_b64 v11, v[34:35] offset:26624
    v_mfma_f32_16x16x32_bf16 v[68:71], v[112:115], a[16:19], v[68:71]
    s_add_u32 s61, s61, 16384
    v_add_f32 v42, v42, v92
    v_add_f32 v42, v42, v93
    v_mfma_f32_16x16x32_bf16 v[68:71], v[116:119], a[20:23], v[68:71]
    buffer_load_dwordx4 v20, s[32:35], s61 offen offset:0 nt lds
    v_mfma_f32_16x16x32_bf16 v[68:71], v[120:123], a[24:27], v[68:71]
    v_add_f32 v42, v42, v94
    v_add_f32 v42, v42, v95
    v_mfma_f32_16x16x32_bf16 v[68:71], v[124:127], a[28:31], v[68:71]
    buffer_load_dwordx4 v21, s[32:35], s61 offen offset:1024 nt lds
    v_mfma_f32_16x16x32_bf16 v[208:211], a[224:227], v[44:47], v[208:211]
    v_mfma_f32_16x16x32_bf16 v[208:211], a[228:231], v[48:51], v[208:211]
    buffer_load_dwordx4 v22, s[32:35], s61 offen offset:2048 nt lds
    v_mfma_f32_16x16x32_bf16 v[212:215], a[232:235], v[44:47], v[212:215]
    v_fma_f32 v68, v68, s3, v240
    v_fma_f32 v69, v69, s3, v240
    v_mfma_f32_16x16x32_bf16 v[212:215], a[236:239], v[48:51], v[212:215]
    v_fma_f32 v70, v70, s3, v240
    v_fma_f32 v71, v71, s3, v240
    v_mfma_f32_16x16x32_bf16 v[216:219], a[240:243], v[44:47], v[216:219]
    buffer_load_dwordx4 v23, s[32:35], s61 offen offset:3072 nt lds
    v_mfma_f32_16x16x32_bf16 v[216:219], a[244:247], v[48:51], v[216:219]
    v_exp_f32 v68, v68
    v_mfma_f32_16x16x32_bf16 v[220:223], a[248:251], v[44:47], v[220:223]
    s_waitcnt lgkmcnt(0)
    v_exp_f32 v69, v69
    v_mfma_f32_16x16x32_bf16 v[220:223], a[252:255], v[48:51], v[220:223]
    s_barrier
    v_exp_f32 v70, v70
    v_mfma_f32_16x16x32_bf16 v[72:75], v[96:99], a[32:35], 0
    v_exp_f32 v71, v71
    v_mfma_f32_16x16x32_bf16 v[72:75], v[100:103], a[36:39], v[72:75]
    v_cvt_pk_bf16_f32 v32, v68, v69
    v_cvt_pk_bf16_f32 v33, v70, v71
    v_mfma_f32_16x16x32_bf16 v[72:75], v[104:107], a[40:43], v[72:75]
    s_nop 0
    ds_read_b128 v[44:47], v10 offset:14336
    ds_read_b128 v[48:51], v10 offset:15360
    v_mfma_f32_16x16x32_bf16 v[72:75], v[108:111], a[44:47], v[72:75]
    s_add_u32 m0, s64, 69632
    ds_write_b64 v11, v[32:33] offset:0
    v_mfma_f32_16x16x32_bf16 v[72:75], v[112:115], a[48:51], v[72:75]
    s_add_u32 s61, s61, 16384
    v_add_f32 v36, v36, v68
    v_add_f32 v36, v36, v69
    v_mfma_f32_16x16x32_bf16 v[72:75], v[116:119], a[52:55], v[72:75]
    buffer_load_dwordx4 v20, s[32:35], s61 offen offset:0 nt lds
    v_mfma_f32_16x16x32_bf16 v[72:75], v[120:123], a[56:59], v[72:75]
    v_add_f32 v36, v36, v70
    v_add_f32 v36, v36, v71
    v_mfma_f32_16x16x32_bf16 v[72:75], v[124:127], a[60:63], v[72:75]
    buffer_load_dwordx4 v21, s[32:35], s61 offen offset:1024 nt lds
    v_mfma_f32_16x16x32_bf16 v[224:227], a[224:227], v[52:55], v[224:227]
    v_mfma_f32_16x16x32_bf16 v[224:227], a[228:231], v[56:59], v[224:227]
    buffer_load_dwordx4 v22, s[32:35], s61 offen offset:2048 nt lds
    v_mfma_f32_16x16x32_bf16 v[228:231], a[232:235], v[52:55], v[228:231]
    s_waitcnt vmcnt(15)
    ds_read_b64_tr_b16 a[224:225], v12 offset:32768
    v_fma_f32 v72, v72, s3, v241
    v_mfma_f32_16x16x32_bf16 v[228:231], a[236:239], v[56:59], v[228:231]
    s_nop 0
    ds_read_b64_tr_b16 a[226:227], v12 offset:33280
    v_fma_f32 v73, v73, s3, v241
    v_mfma_f32_16x16x32_bf16 v[232:235], a[240:243], v[52:55], v[232:235]
    s_nop 0
    ds_read_b64_tr_b16 a[228:229], v12 offset:33792
    v_fma_f32 v74, v74, s3, v241
    v_mfma_f32_16x16x32_bf16 v[232:235], a[244:247], v[56:59], v[232:235]
    s_nop 0
    ds_read_b64_tr_b16 a[230:231], v12 offset:34304
    v_fma_f32 v75, v75, s3, v241
    v_mfma_f32_16x16x32_bf16 v[236:239], a[248:251], v[52:55], v[236:239]
    v_exp_f32 v72, v72
    v_mfma_f32_16x16x32_bf16 v[236:239], a[252:255], v[56:59], v[236:239]
    v_exp_f32 v73, v73
    v_mfma_f32_16x16x32_bf16 v[76:79], v[96:99], a[64:67], 0
    v_exp_f32 v74, v74
    v_mfma_f32_16x16x32_bf16 v[76:79], v[100:103], a[68:71], v[76:79]
    v_exp_f32 v75, v75
    v_mfma_f32_16x16x32_bf16 v[76:79], v[104:107], a[72:75], v[76:79]
    s_nop 0
    ds_read_b64_tr_b16 a[232:233], v13 offset:32768
    ds_read_b64_tr_b16 a[234:235], v13 offset:33280
    v_mfma_f32_16x16x32_bf16 v[76:79], v[108:111], a[76:79], v[76:79]
    s_nop 0
    ds_read_b64_tr_b16 a[236:237], v13 offset:33792
    ds_read_b64_tr_b16 a[238:239], v13 offset:34304
    v_mfma_f32_16x16x32_bf16 v[76:79], v[112:115], a[80:83], v[76:79]
    s_nop 0
    ds_read_b64_tr_b16 a[240:241], v14 offset:32768
    ds_read_b64_tr_b16 a[242:243], v14 offset:33280
    v_mfma_f32_16x16x32_bf16 v[76:79], v[116:119], a[84:87], v[76:79]
    s_nop 0
    ds_read_b64_tr_b16 a[244:245], v14 offset:33792
    ds_read_b64_tr_b16 a[246:247], v14 offset:34304
    v_mfma_f32_16x16x32_bf16 v[76:79], v[120:123], a[88:91], v[76:79]
    s_nop 0
    ds_read_b64_tr_b16 a[248:249], v15 offset:32768
    ds_read_b64_tr_b16 a[250:251], v15 offset:33280
    v_mfma_f32_16x16x32_bf16 v[76:79], v[124:127], a[92:95], v[76:79]
    s_waitcnt lgkmcnt(10)
    ds_read_b64_tr_b16 a[252:253], v15 offset:33792
    ds_read_b64_tr_b16 a[254:255], v15 offset:34304
    v_mfma_f32_16x16x32_bf16 v[128:131], a[224:227], v[44:47], v[128:131]
    v_cvt_pk_bf16_f32 v34, v72, v73
    v_cvt_pk_bf16_f32 v35, v74, v75
    v_mfma_f32_16x16x32_bf16 v[128:131], a[228:231], v[48:51], v[128:131]
    s_waitcnt lgkmcnt(10)
    ds_read_b128 v[52:55], v10 offset:16384
    ds_read_b128 v[56:59], v10 offset:17408
    v_mfma_f32_16x16x32_bf16 v[132:135], a[232:235], v[44:47], v[132:135]
    s_waitcnt lgkmcnt(10)
    ds_write_b64 v11, v[34:35] offset:2048
    v_mfma_f32_16x16x32_bf16 v[132:135], a[236:239], v[48:51], v[132:135]
    s_waitcnt lgkmcnt(9)
    v_add_f32 v37, v37, v72
    v_add_f32 v37, v37, v73
    v_mfma_f32_16x16x32_bf16 v[136:139], a[240:243], v[44:47], v[136:139]
    s_waitcnt lgkmcnt(7)
    v_add_f32 v37, v37, v74
    v_add_f32 v37, v37, v75
    v_mfma_f32_16x16x32_bf16 v[136:139], a[244:247], v[48:51], v[136:139]
    s_waitcnt lgkmcnt(5)
    v_fma_f32 v76, v76, s3, v242
    v_fma_f32 v77, v77, s3, v242
    v_mfma_f32_16x16x32_bf16 v[140:143], a[248:251], v[44:47], v[140:143]
    s_waitcnt lgkmcnt(3)
    v_fma_f32 v78, v78, s3, v242
    v_fma_f32 v79, v79, s3, v242
    v_mfma_f32_16x16x32_bf16 v[140:143], a[252:255], v[48:51], v[140:143]
    v_exp_f32 v76, v76
    v_mfma_f32_16x16x32_bf16 v[80:83], v[96:99], a[96:99], 0
    v_exp_f32 v77, v77
    v_mfma_f32_16x16x32_bf16 v[80:83], v[100:103], a[100:103], v[80:83]
    v_exp_f32 v78, v78
    v_mfma_f32_16x16x32_bf16 v[80:83], v[104:107], a[104:107], v[80:83]
    v_exp_f32 v79, v79
    v_mfma_f32_16x16x32_bf16 v[80:83], v[108:111], a[108:111], v[80:83]
    v_cvt_pk_bf16_f32 v32, v76, v77
    v_cvt_pk_bf16_f32 v33, v78, v79
    v_mfma_f32_16x16x32_bf16 v[80:83], v[112:115], a[112:115], v[80:83]
    s_nop 0
    ds_read_b128 v[44:47], v10 offset:18432
    ds_read_b128 v[48:51], v10 offset:19456
    v_mfma_f32_16x16x32_bf16 v[80:83], v[116:119], a[116:119], v[80:83]
    ds_write_b64 v11, v[32:33] offset:4096
    v_mfma_f32_16x16x32_bf16 v[80:83], v[120:123], a[120:123], v[80:83]
    v_add_f32 v38, v38, v76
    v_add_f32 v38, v38, v77
    v_mfma_f32_16x16x32_bf16 v[80:83], v[124:127], a[124:127], v[80:83]
    s_waitcnt lgkmcnt(3)
    v_add_f32 v38, v38, v78
    v_add_f32 v38, v38, v79
    v_mfma_f32_16x16x32_bf16 v[144:147], a[224:227], v[52:55], v[144:147]
    buffer_load_dwordx4 v23, s[32:35], s61 offen offset:3072 nt lds
    v_mfma_f32_16x16x32_bf16 v[144:147], a[228:231], v[56:59], v[144:147]
    global_load_dword v6, v247, s[4:5]
    v_mfma_f32_16x16x32_bf16 v[148:151], a[232:235], v[52:55], v[148:151]
    v_fma_f32 v80, v80, s3, v243
    v_fma_f32 v81, v81, s3, v243
    v_mfma_f32_16x16x32_bf16 v[148:151], a[236:239], v[56:59], v[148:151]
    s_add_u32 m0, s64, 0
    v_fma_f32 v82, v82, s3, v243
    v_fma_f32 v83, v83, s3, v243
    v_mfma_f32_16x16x32_bf16 v[152:155], a[240:243], v[52:55], v[152:155]
    s_add_u32 s60, s60, 16384
    v_exp_f32 v80, v80
    v_mfma_f32_16x16x32_bf16 v[152:155], a[244:247], v[56:59], v[152:155]
    buffer_load_dwordx4 v24, s[28:31], s60 offen offset:0 nt lds
    v_mfma_f32_16x16x32_bf16 v[156:159], a[248:251], v[52:55], v[156:159]
    v_exp_f32 v81, v81
    v_mfma_f32_16x16x32_bf16 v[156:159], a[252:255], v[56:59], v[156:159]
    v_exp_f32 v82, v82
    v_mfma_f32_16x16x32_bf16 v[84:87], v[96:99], a[128:131], 0
    v_exp_f32 v83, v83
    v_mfma_f32_16x16x32_bf16 v[84:87], v[100:103], a[132:135], v[84:87]
    v_cvt_pk_bf16_f32 v34, v80, v81
    v_cvt_pk_bf16_f32 v35, v82, v83
    v_mfma_f32_16x16x32_bf16 v[84:87], v[104:107], a[136:139], v[84:87]
    s_nop 0
    ds_read_b128 v[52:55], v10 offset:20480
    ds_read_b128 v[56:59], v10 offset:21504
    v_mfma_f32_16x16x32_bf16 v[84:87], v[108:111], a[140:143], v[84:87]
    ds_write_b64 v11, v[34:35] offset:6144
    v_mfma_f32_16x16x32_bf16 v[84:87], v[112:115], a[144:147], v[84:87]
    v_add_f32 v39, v39, v80
    v_add_f32 v39, v39, v81
    v_mfma_f32_16x16x32_bf16 v[84:87], v[116:119], a[148:151], v[84:87]
    buffer_load_dwordx4 v25, s[28:31], s60 offen offset:1024 nt lds
    v_mfma_f32_16x16x32_bf16 v[84:87], v[120:123], a[152:155], v[84:87]
    v_add_f32 v39, v39, v82
    v_add_f32 v39, v39, v83
    v_mfma_f32_16x16x32_bf16 v[84:87], v[124:127], a[156:159], v[84:87]
    s_waitcnt lgkmcnt(3)
    v_mfma_f32_16x16x32_bf16 v[160:163], a[224:227], v[44:47], v[160:163]
    buffer_load_dwordx4 v26, s[28:31], s60 offen offset:2048 nt lds
    v_mfma_f32_16x16x32_bf16 v[160:163], a[228:231], v[48:51], v[160:163]
    v_mfma_f32_16x16x32_bf16 v[164:167], a[232:235], v[44:47], v[164:167]
    v_fma_f32 v84, v84, s3, v244
    v_fma_f32 v85, v85, s3, v244
    v_mfma_f32_16x16x32_bf16 v[164:167], a[236:239], v[48:51], v[164:167]
    v_fma_f32 v86, v86, s3, v244
    v_fma_f32 v87, v87, s3, v244
    v_mfma_f32_16x16x32_bf16 v[168:171], a[240:243], v[44:47], v[168:171]
    v_exp_f32 v84, v84
    v_mfma_f32_16x16x32_bf16 v[168:171], a[244:247], v[48:51], v[168:171]
    buffer_load_dwordx4 v27, s[28:31], s60 offen offset:3072 nt lds
    v_mfma_f32_16x16x32_bf16 v[172:175], a[248:251], v[44:47], v[172:175]
    v_exp_f32 v85, v85
    v_mfma_f32_16x16x32_bf16 v[172:175], a[252:255], v[48:51], v[172:175]
    v_exp_f32 v86, v86
    v_mfma_f32_16x16x32_bf16 v[88:91], v[96:99], a[160:163], 0
    v_exp_f32 v87, v87
    v_mfma_f32_16x16x32_bf16 v[88:91], v[100:103], a[164:167], v[88:91]
    v_cvt_pk_bf16_f32 v32, v84, v85
    v_cvt_pk_bf16_f32 v33, v86, v87
    v_mfma_f32_16x16x32_bf16 v[88:91], v[104:107], a[168:171], v[88:91]
    s_nop 0
    ds_read_b128 v[44:47], v10 offset:22528
    ds_read_b128 v[48:51], v10 offset:23552
    v_mfma_f32_16x16x32_bf16 v[88:91], v[108:111], a[172:175], v[88:91]
    s_add_u32 m0, s64, 4096
    ds_write_b64 v11, v[32:33] offset:8192
    v_mfma_f32_16x16x32_bf16 v[88:91], v[112:115], a[176:179], v[88:91]
    s_add_u32 s60, s60, 16384
    v_add_f32 v40, v40, v84
    v_add_f32 v40, v40, v85
    v_mfma_f32_16x16x32_bf16 v[88:91], v[116:119], a[180:183], v[88:91]
    buffer_load_dwordx4 v28, s[28:31], s60 offen offset:0 nt lds
    v_mfma_f32_16x16x32_bf16 v[88:91], v[120:123], a[184:187], v[88:91]
    s_waitcnt lgkmcnt(3)
    v_add_f32 v40, v40, v86
    v_add_f32 v40, v40, v87
    v_mfma_f32_16x16x32_bf16 v[88:91], v[124:127], a[188:191], v[88:91]
    buffer_load_dwordx4 v29, s[28:31], s60 offen offset:1024 nt lds
    v_mfma_f32_16x16x32_bf16 v[176:179], a[224:227], v[52:55], v[176:179]
    v_mfma_f32_16x16x32_bf16 v[176:179], a[228:231], v[56:59], v[176:179]
    buffer_load_dwordx4 v30, s[28:31], s60 offen offset:2048 nt lds
    v_mfma_f32_16x16x32_bf16 v[180:183], a[232:235], v[52:55], v[180:183]
    v_fma_f32 v88, v88, s3, v245
    v_fma_f32 v89, v89, s3, v245
    v_mfma_f32_16x16x32_bf16 v[180:183], a[236:239], v[56:59], v[180:183]
    v_fma_f32 v90, v90, s3, v245
    v_fma_f32 v91, v91, s3, v245
    v_mfma_f32_16x16x32_bf16 v[184:187], a[240:243], v[52:55], v[184:187]
    v_exp_f32 v88, v88
    v_mfma_f32_16x16x32_bf16 v[184:187], a[244:247], v[56:59], v[184:187]
    v_exp_f32 v89, v89
    v_mfma_f32_16x16x32_bf16 v[188:191], a[248:251], v[52:55], v[188:191]
    v_exp_f32 v90, v90
    v_mfma_f32_16x16x32_bf16 v[188:191], a[252:255], v[56:59], v[188:191]
    v_exp_f32 v91, v91
    v_mfma_f32_16x16x32_bf16 v[92:95], v[96:99], a[192:195], 0
    s_waitcnt vmcnt(16)
    ds_read_b128 v[52:55], v10 offset:24576
    ds_read_b128 v[56:59], v10 offset:25600
    v_mfma_f32_16x16x32_bf16 v[92:95], v[100:103], a[196:199], v[92:95]
    s_nop 0
    ds_read_b128 v[96:99], v16 offset:32768
    v_cvt_pk_bf16_f32 v34, v88, v89
    v_mfma_f32_16x16x32_bf16 v[92:95], v[104:107], a[200:203], v[92:95]
    s_nop 0
    ds_read_b128 v[100:103], v17 offset:32768
    v_cvt_pk_bf16_f32 v35, v90, v91
    v_mfma_f32_16x16x32_bf16 v[92:95], v[108:111], a[204:207], v[92:95]
    s_nop 0
    ds_read_b128 v[104:107], v18 offset:32768
    v_add_f32 v41, v41, v88
    v_mfma_f32_16x16x32_bf16 v[92:95], v[112:115], a[208:211], v[92:95]
    s_nop 0
    ds_read_b128 v[108:111], v19 offset:32768
    v_add_f32 v41, v41, v89
    v_mfma_f32_16x16x32_bf16 v[92:95], v[116:119], a[212:215], v[92:95]
    s_nop 0
    ds_read_b128 v[112:115], v16 offset:33024
    v_add_f32 v41, v41, v90
    v_mfma_f32_16x16x32_bf16 v[92:95], v[120:123], a[216:219], v[92:95]
    s_nop 0
    ds_read_b128 v[116:119], v17 offset:33024
    v_add_f32 v41, v41, v91
    v_mfma_f32_16x16x32_bf16 v[92:95], v[124:127], a[220:223], v[92:95]
    s_waitcnt lgkmcnt(8)
    ds_read_b128 v[120:123], v18 offset:33024
    v_mfma_f32_16x16x32_bf16 v[192:195], a[224:227], v[44:47], v[192:195]
    s_nop 0
    ds_read_b128 v[124:127], v19 offset:33024
    v_mfma_f32_16x16x32_bf16 v[192:195], a[228:231], v[48:51], v[192:195]
    ds_write_b64 v11, v[34:35] offset:10240
    v_mfma_f32_16x16x32_bf16 v[196:199], a[232:235], v[44:47], v[196:199]
    v_fma_f32 v92, v92, s3, v246
    v_fma_f32 v93, v93, s3, v246
    v_mfma_f32_16x16x32_bf16 v[196:199], a[236:239], v[48:51], v[196:199]
    v_fma_f32 v94, v94, s3, v246
    v_fma_f32 v95, v95, s3, v246
    v_mfma_f32_16x16x32_bf16 v[200:203], a[240:243], v[44:47], v[200:203]
    buffer_load_dwordx4 v31, s[28:31], s60 offen offset:3072 nt lds
    v_mfma_f32_16x16x32_bf16 v[200:203], a[244:247], v[48:51], v[200:203]
    v_exp_f32 v92, v92
    v_mfma_f32_16x16x32_bf16 v[204:207], a[248:251], v[44:47], v[204:207]
    v_exp_f32 v93, v93
    v_mfma_f32_16x16x32_bf16 v[204:207], a[252:255], v[48:51], v[204:207]
    s_waitcnt lgkmcnt(1)
    v_exp_f32 v94, v94
    v_mfma_f32_16x16x32_bf16 v[68:71], v[96:99], a[0:3], 0
    v_exp_f32 v95, v95
    v_mfma_f32_16x16x32_bf16 v[68:71], v[100:103], a[4:7], v[68:71]
    v_cvt_pk_bf16_f32 v32, v92, v93
    v_cvt_pk_bf16_f32 v33, v94, v95
    v_mfma_f32_16x16x32_bf16 v[68:71], v[104:107], a[8:11], v[68:71]
    s_nop 0
    ds_read_b128 v[44:47], v10 offset:26624
    ds_read_b128 v[48:51], v10 offset:27648
    v_mfma_f32_16x16x32_bf16 v[68:71], v[108:111], a[12:15], v[68:71]
    s_add_u32 m0, s64, 98304
    ds_write_b64 v11, v[32:33] offset:12288
    v_mfma_f32_16x16x32_bf16 v[68:71], v[112:115], a[16:19], v[68:71]
    s_add_u32 s61, s61, 16384
    v_add_f32 v42, v42, v92
    v_add_f32 v42, v42, v93
    v_mfma_f32_16x16x32_bf16 v[68:71], v[116:119], a[20:23], v[68:71]
    buffer_load_dwordx4 v20, s[32:35], s61 offen offset:0 nt lds
    v_mfma_f32_16x16x32_bf16 v[68:71], v[120:123], a[24:27], v[68:71]
    v_add_f32 v42, v42, v94
    v_add_f32 v42, v42, v95
    v_mfma_f32_16x16x32_bf16 v[68:71], v[124:127], a[28:31], v[68:71]
    buffer_load_dwordx4 v21, s[32:35], s61 offen offset:1024 nt lds
    v_mfma_f32_16x16x32_bf16 v[208:211], a[224:227], v[52:55], v[208:211]
    v_mfma_f32_16x16x32_bf16 v[208:211], a[228:231], v[56:59], v[208:211]
    buffer_load_dwordx4 v22, s[32:35], s61 offen offset:2048 nt lds
    v_mfma_f32_16x16x32_bf16 v[212:215], a[232:235], v[52:55], v[212:215]
    v_fma_f32 v68, v68, s3, v240
    v_fma_f32 v69, v69, s3, v240
    v_mfma_f32_16x16x32_bf16 v[212:215], a[236:239], v[56:59], v[212:215]
    v_fma_f32 v70, v70, s3, v240
    v_fma_f32 v71, v71, s3, v240
    v_mfma_f32_16x16x32_bf16 v[216:219], a[240:243], v[52:55], v[216:219]
    buffer_load_dwordx4 v23, s[32:35], s61 offen offset:3072 nt lds
    v_mfma_f32_16x16x32_bf16 v[216:219], a[244:247], v[56:59], v[216:219]
    v_exp_f32 v68, v68
    v_mfma_f32_16x16x32_bf16 v[220:223], a[248:251], v[52:55], v[220:223]
    s_waitcnt lgkmcnt(0)
    v_exp_f32 v69, v69
    v_mfma_f32_16x16x32_bf16 v[220:223], a[252:255], v[56:59], v[220:223]
    s_barrier
    v_exp_f32 v70, v70
    v_mfma_f32_16x16x32_bf16 v[72:75], v[96:99], a[32:35], 0
    v_exp_f32 v71, v71
    v_mfma_f32_16x16x32_bf16 v[72:75], v[100:103], a[36:39], v[72:75]
    v_cvt_pk_bf16_f32 v34, v68, v69
    v_cvt_pk_bf16_f32 v35, v70, v71
    v_mfma_f32_16x16x32_bf16 v[72:75], v[104:107], a[40:43], v[72:75]
    s_nop 0
    ds_read_b128 v[52:55], v10 offset:0
    ds_read_b128 v[56:59], v10 offset:1024
    v_mfma_f32_16x16x32_bf16 v[72:75], v[108:111], a[44:47], v[72:75]
    s_add_u32 m0, s64, 102400
    ds_write_b64 v11, v[34:35] offset:14336
    v_mfma_f32_16x16x32_bf16 v[72:75], v[112:115], a[48:51], v[72:75]
    s_add_u32 s61, s61, 16384
    v_add_f32 v36, v36, v68
    v_add_f32 v36, v36, v69
    v_mfma_f32_16x16x32_bf16 v[72:75], v[116:119], a[52:55], v[72:75]
    buffer_load_dwordx4 v20, s[32:35], s61 offen offset:0 nt lds
    v_mfma_f32_16x16x32_bf16 v[72:75], v[120:123], a[56:59], v[72:75]
    v_add_f32 v36, v36, v70
    v_add_f32 v36, v36, v71
    v_mfma_f32_16x16x32_bf16 v[72:75], v[124:127], a[60:63], v[72:75]
    buffer_load_dwordx4 v21, s[32:35], s61 offen offset:1024 nt lds
    v_mfma_f32_16x16x32_bf16 v[224:227], a[224:227], v[44:47], v[224:227]
    v_mfma_f32_16x16x32_bf16 v[224:227], a[228:231], v[48:51], v[224:227]
    buffer_load_dwordx4 v22, s[32:35], s61 offen offset:2048 nt lds
    v_mfma_f32_16x16x32_bf16 v[228:231], a[232:235], v[44:47], v[228:231]
    s_waitcnt vmcnt(16)
    ds_read_b64_tr_b16 a[224:225], v12 offset:0
    v_fma_f32 v72, v72, s3, v241
    v_mfma_f32_16x16x32_bf16 v[228:231], a[236:239], v[48:51], v[228:231]
    s_nop 0
    ds_read_b64_tr_b16 a[226:227], v12 offset:512
    v_fma_f32 v73, v73, s3, v241
    v_mfma_f32_16x16x32_bf16 v[232:235], a[240:243], v[44:47], v[232:235]
    s_nop 0
    ds_read_b64_tr_b16 a[228:229], v12 offset:1024
    v_fma_f32 v74, v74, s3, v241
    v_mfma_f32_16x16x32_bf16 v[232:235], a[244:247], v[48:51], v[232:235]
    s_nop 0
    ds_read_b64_tr_b16 a[230:231], v12 offset:1536
    v_fma_f32 v75, v75, s3, v241
    v_mfma_f32_16x16x32_bf16 v[236:239], a[248:251], v[44:47], v[236:239]
    v_exp_f32 v72, v72
    v_mfma_f32_16x16x32_bf16 v[236:239], a[252:255], v[48:51], v[236:239]
    v_exp_f32 v73, v73
    v_mfma_f32_16x16x32_bf16 v[76:79], v[96:99], a[64:67], 0
    v_exp_f32 v74, v74
    v_mfma_f32_16x16x32_bf16 v[76:79], v[100:103], a[68:71], v[76:79]
    v_exp_f32 v75, v75
    v_mfma_f32_16x16x32_bf16 v[76:79], v[104:107], a[72:75], v[76:79]
    s_nop 0
    ds_read_b64_tr_b16 a[232:233], v13 offset:0
    ds_read_b64_tr_b16 a[234:235], v13 offset:512
    v_mfma_f32_16x16x32_bf16 v[76:79], v[108:111], a[76:79], v[76:79]
    s_nop 0
    ds_read_b64_tr_b16 a[236:237], v13 offset:1024
    ds_read_b64_tr_b16 a[238:239], v13 offset:1536
    v_mfma_f32_16x16x32_bf16 v[76:79], v[112:115], a[80:83], v[76:79]
    s_nop 0
    ds_read_b64_tr_b16 a[240:241], v14 offset:0
    ds_read_b64_tr_b16 a[242:243], v14 offset:512
    v_mfma_f32_16x16x32_bf16 v[76:79], v[116:119], a[84:87], v[76:79]
    s_nop 0
    ds_read_b64_tr_b16 a[244:245], v14 offset:1024
    ds_read_b64_tr_b16 a[246:247], v14 offset:1536
    v_mfma_f32_16x16x32_bf16 v[76:79], v[120:123], a[88:91], v[76:79]
    s_nop 0
    ds_read_b64_tr_b16 a[248:249], v15 offset:0
    ds_read_b64_tr_b16 a[250:251], v15 offset:512
    v_mfma_f32_16x16x32_bf16 v[76:79], v[124:127], a[92:95], v[76:79]
    s_waitcnt lgkmcnt(10)
    ds_read_b64_tr_b16 a[252:253], v15 offset:1024
    ds_read_b64_tr_b16 a[254:255], v15 offset:1536
    v_mfma_f32_16x16x32_bf16 v[128:131], a[224:227], v[52:55], v[128:131]
    v_cvt_pk_bf16_f32 v32, v72, v73
    v_cvt_pk_bf16_f32 v33, v74, v75
    v_mfma_f32_16x16x32_bf16 v[128:131], a[228:231], v[56:59], v[128:131]
    s_waitcnt lgkmcnt(10)
    ds_read_b128 v[44:47], v10 offset:2048
    ds_read_b128 v[48:51], v10 offset:3072
    v_mfma_f32_16x16x32_bf16 v[132:135], a[232:235], v[52:55], v[132:135]
    s_waitcnt lgkmcnt(10)
    ds_write_b64 v11, v[32:33] offset:16384
    v_mfma_f32_16x16x32_bf16 v[132:135], a[236:239], v[56:59], v[132:135]
    s_waitcnt lgkmcnt(9)
    v_add_f32 v37, v37, v72
    v_add_f32 v37, v37, v73
    v_mfma_f32_16x16x32_bf16 v[136:139], a[240:243], v[52:55], v[136:139]
    s_waitcnt lgkmcnt(7)
    v_add_f32 v37, v37, v74
    v_add_f32 v37, v37, v75
    v_mfma_f32_16x16x32_bf16 v[136:139], a[244:247], v[56:59], v[136:139]
    s_waitcnt lgkmcnt(5)
    v_fma_f32 v76, v76, s3, v242
    v_fma_f32 v77, v77, s3, v242
    v_mfma_f32_16x16x32_bf16 v[140:143], a[248:251], v[52:55], v[140:143]
    s_waitcnt lgkmcnt(3)
    v_fma_f32 v78, v78, s3, v242
    v_fma_f32 v79, v79, s3, v242
    v_mfma_f32_16x16x32_bf16 v[140:143], a[252:255], v[56:59], v[140:143]
    v_exp_f32 v76, v76
    v_mfma_f32_16x16x32_bf16 v[80:83], v[96:99], a[96:99], 0
    v_exp_f32 v77, v77
    v_mfma_f32_16x16x32_bf16 v[80:83], v[100:103], a[100:103], v[80:83]
    v_exp_f32 v78, v78
    v_mfma_f32_16x16x32_bf16 v[80:83], v[104:107], a[104:107], v[80:83]
    v_exp_f32 v79, v79
    v_mfma_f32_16x16x32_bf16 v[80:83], v[108:111], a[108:111], v[80:83]
    v_cvt_pk_bf16_f32 v34, v76, v77
    v_cvt_pk_bf16_f32 v35, v78, v79
    v_mfma_f32_16x16x32_bf16 v[80:83], v[112:115], a[112:115], v[80:83]
    s_nop 0
    ds_read_b128 v[52:55], v10 offset:4096
    ds_read_b128 v[56:59], v10 offset:5120
    v_mfma_f32_16x16x32_bf16 v[80:83], v[116:119], a[116:119], v[80:83]
    ds_write_b64 v11, v[34:35] offset:18432
    v_mfma_f32_16x16x32_bf16 v[80:83], v[120:123], a[120:123], v[80:83]
    v_add_f32 v38, v38, v76
    v_add_f32 v38, v38, v77
    v_mfma_f32_16x16x32_bf16 v[80:83], v[124:127], a[124:127], v[80:83]
    s_waitcnt lgkmcnt(3)
    v_add_f32 v38, v38, v78
    v_add_f32 v38, v38, v79
    v_mfma_f32_16x16x32_bf16 v[144:147], a[224:227], v[44:47], v[144:147]
    buffer_load_dwordx4 v23, s[32:35], s61 offen offset:3072 nt lds
    v_mfma_f32_16x16x32_bf16 v[144:147], a[228:231], v[48:51], v[144:147]
    v_mfma_f32_16x16x32_bf16 v[148:151], a[232:235], v[44:47], v[148:151]
    v_fma_f32 v80, v80, s3, v243
    v_fma_f32 v81, v81, s3, v243
    v_mfma_f32_16x16x32_bf16 v[148:151], a[236:239], v[48:51], v[148:151]
    s_add_u32 m0, s64, 32768
    v_fma_f32 v82, v82, s3, v243
    v_fma_f32 v83, v83, s3, v243
    v_mfma_f32_16x16x32_bf16 v[152:155], a[240:243], v[44:47], v[152:155]
    s_add_u32 s60, s60, 16384
    v_exp_f32 v80, v80
    v_mfma_f32_16x16x32_bf16 v[152:155], a[244:247], v[48:51], v[152:155]
    buffer_load_dwordx4 v24, s[28:31], s60 offen offset:0 nt lds
    v_mfma_f32_16x16x32_bf16 v[156:159], a[248:251], v[44:47], v[156:159]
    v_exp_f32 v81, v81
    v_mfma_f32_16x16x32_bf16 v[156:159], a[252:255], v[48:51], v[156:159]
    v_exp_f32 v82, v82
    v_mfma_f32_16x16x32_bf16 v[84:87], v[96:99], a[128:131], 0
    v_exp_f32 v83, v83
    v_mfma_f32_16x16x32_bf16 v[84:87], v[100:103], a[132:135], v[84:87]
    v_cvt_pk_bf16_f32 v32, v80, v81
    v_cvt_pk_bf16_f32 v33, v82, v83
    v_mfma_f32_16x16x32_bf16 v[84:87], v[104:107], a[136:139], v[84:87]
    s_nop 0
    ds_read_b128 v[44:47], v10 offset:6144
    ds_read_b128 v[48:51], v10 offset:7168
    v_mfma_f32_16x16x32_bf16 v[84:87], v[108:111], a[140:143], v[84:87]
    ds_write_b64 v11, v[32:33] offset:20480
    v_mfma_f32_16x16x32_bf16 v[84:87], v[112:115], a[144:147], v[84:87]
    v_add_f32 v39, v39, v80
    v_add_f32 v39, v39, v81
    v_mfma_f32_16x16x32_bf16 v[84:87], v[116:119], a[148:151], v[84:87]
    buffer_load_dwordx4 v25, s[28:31], s60 offen offset:1024 nt lds
    v_mfma_f32_16x16x32_bf16 v[84:87], v[120:123], a[152:155], v[84:87]
    v_add_f32 v39, v39, v82
    v_add_f32 v39, v39, v83
    v_mfma_f32_16x16x32_bf16 v[84:87], v[124:127], a[156:159], v[84:87]
    s_waitcnt lgkmcnt(3)
    v_mfma_f32_16x16x32_bf16 v[160:163], a[224:227], v[52:55], v[160:163]
    buffer_load_dwordx4 v26, s[28:31], s60 offen offset:2048 nt lds
    v_mfma_f32_16x16x32_bf16 v[160:163], a[228:231], v[56:59], v[160:163]
    v_mfma_f32_16x16x32_bf16 v[164:167], a[232:235], v[52:55], v[164:167]
    v_fma_f32 v84, v84, s3, v244
    v_fma_f32 v85, v85, s3, v244
    v_mfma_f32_16x16x32_bf16 v[164:167], a[236:239], v[56:59], v[164:167]
    v_fma_f32 v86, v86, s3, v244
    v_fma_f32 v87, v87, s3, v244
    v_mfma_f32_16x16x32_bf16 v[168:171], a[240:243], v[52:55], v[168:171]
    v_exp_f32 v84, v84
    v_mfma_f32_16x16x32_bf16 v[168:171], a[244:247], v[56:59], v[168:171]
    buffer_load_dwordx4 v27, s[28:31], s60 offen offset:3072 nt lds
    v_mfma_f32_16x16x32_bf16 v[172:175], a[248:251], v[52:55], v[172:175]
    v_exp_f32 v85, v85
    v_mfma_f32_16x16x32_bf16 v[172:175], a[252:255], v[56:59], v[172:175]
    v_exp_f32 v86, v86
    v_mfma_f32_16x16x32_bf16 v[88:91], v[96:99], a[160:163], 0
    v_exp_f32 v87, v87
    v_mfma_f32_16x16x32_bf16 v[88:91], v[100:103], a[164:167], v[88:91]
    v_cvt_pk_bf16_f32 v34, v84, v85
    v_cvt_pk_bf16_f32 v35, v86, v87
    v_mfma_f32_16x16x32_bf16 v[88:91], v[104:107], a[168:171], v[88:91]
    s_nop 0
    ds_read_b128 v[52:55], v10 offset:8192
    ds_read_b128 v[56:59], v10 offset:9216
    v_mfma_f32_16x16x32_bf16 v[88:91], v[108:111], a[172:175], v[88:91]
    s_add_u32 m0, s64, 36864
    ds_write_b64 v11, v[34:35] offset:22528
    v_mfma_f32_16x16x32_bf16 v[88:91], v[112:115], a[176:179], v[88:91]
    s_add_u32 s60, s60, 16384
    v_add_f32 v40, v40, v84
    v_add_f32 v40, v40, v85
    v_mfma_f32_16x16x32_bf16 v[88:91], v[116:119], a[180:183], v[88:91]
    buffer_load_dwordx4 v28, s[28:31], s60 offen offset:0 nt lds
    v_mfma_f32_16x16x32_bf16 v[88:91], v[120:123], a[184:187], v[88:91]
    s_waitcnt lgkmcnt(3)
    v_add_f32 v40, v40, v86
    v_add_f32 v40, v40, v87
    v_mfma_f32_16x16x32_bf16 v[88:91], v[124:127], a[188:191], v[88:91]
    buffer_load_dwordx4 v29, s[28:31], s60 offen offset:1024 nt lds
    v_mfma_f32_16x16x32_bf16 v[176:179], a[224:227], v[44:47], v[176:179]
    v_mfma_f32_16x16x32_bf16 v[176:179], a[228:231], v[48:51], v[176:179]
    buffer_load_dwordx4 v30, s[28:31], s60 offen offset:2048 nt lds
    v_mfma_f32_16x16x32_bf16 v[180:183], a[232:235], v[44:47], v[180:183]
    v_fma_f32 v88, v88, s3, v245
    v_fma_f32 v89, v89, s3, v245
    v_mfma_f32_16x16x32_bf16 v[180:183], a[236:239], v[48:51], v[180:183]
    v_fma_f32 v90, v90, s3, v245
    v_fma_f32 v91, v91, s3, v245
    v_mfma_f32_16x16x32_bf16 v[184:187], a[240:243], v[44:47], v[184:187]
    v_exp_f32 v88, v88
    v_mfma_f32_16x16x32_bf16 v[184:187], a[244:247], v[48:51], v[184:187]
    v_exp_f32 v89, v89
    v_mfma_f32_16x16x32_bf16 v[188:191], a[248:251], v[44:47], v[188:191]
    v_exp_f32 v90, v90
    v_mfma_f32_16x16x32_bf16 v[188:191], a[252:255], v[48:51], v[188:191]
    v_exp_f32 v91, v91
    v_mfma_f32_16x16x32_bf16 v[92:95], v[96:99], a[192:195], 0
    s_waitcnt vmcnt(15)
    ds_read_b128 v[44:47], v10 offset:10240
    ds_read_b128 v[48:51], v10 offset:11264
    v_mfma_f32_16x16x32_bf16 v[92:95], v[100:103], a[196:199], v[92:95]
    s_nop 0
    ds_read_b128 v[96:99], v16 offset:0
    v_cvt_pk_bf16_f32 v32, v88, v89
    v_mfma_f32_16x16x32_bf16 v[92:95], v[104:107], a[200:203], v[92:95]
    s_nop 0
    ds_read_b128 v[100:103], v17 offset:0
    v_cvt_pk_bf16_f32 v33, v90, v91
    v_mfma_f32_16x16x32_bf16 v[92:95], v[108:111], a[204:207], v[92:95]
    s_nop 0
    ds_read_b128 v[104:107], v18 offset:0
    v_add_f32 v41, v41, v88
    v_mfma_f32_16x16x32_bf16 v[92:95], v[112:115], a[208:211], v[92:95]
    s_nop 0
    ds_read_b128 v[108:111], v19 offset:0
    v_add_f32 v41, v41, v89
    v_mfma_f32_16x16x32_bf16 v[92:95], v[116:119], a[212:215], v[92:95]
    s_nop 0
    ds_read_b128 v[112:115], v16 offset:256
    v_add_f32 v41, v41, v90
    v_mfma_f32_16x16x32_bf16 v[92:95], v[120:123], a[216:219], v[92:95]
    s_nop 0
    ds_read_b128 v[116:119], v17 offset:256
    v_add_f32 v41, v41, v91
    v_mfma_f32_16x16x32_bf16 v[92:95], v[124:127], a[220:223], v[92:95]
    s_waitcnt lgkmcnt(8)
    ds_read_b128 v[120:123], v18 offset:256
    v_mfma_f32_16x16x32_bf16 v[192:195], a[224:227], v[52:55], v[192:195]
    s_nop 0
    ds_read_b128 v[124:127], v19 offset:256
    v_mfma_f32_16x16x32_bf16 v[192:195], a[228:231], v[56:59], v[192:195]
    ds_write_b64 v11, v[32:33] offset:24576
    v_mfma_f32_16x16x32_bf16 v[196:199], a[232:235], v[52:55], v[196:199]
    v_fma_f32 v92, v92, s3, v246
    v_fma_f32 v93, v93, s3, v246
    v_mfma_f32_16x16x32_bf16 v[196:199], a[236:239], v[56:59], v[196:199]
    v_fma_f32 v94, v94, s3, v246
    v_fma_f32 v95, v95, s3, v246
    v_mfma_f32_16x16x32_bf16 v[200:203], a[240:243], v[52:55], v[200:203]
    buffer_load_dwordx4 v31, s[28:31], s60 offen offset:3072 nt lds
    v_mfma_f32_16x16x32_bf16 v[200:203], a[244:247], v[56:59], v[200:203]
    v_exp_f32 v92, v92
    v_mfma_f32_16x16x32_bf16 v[204:207], a[248:251], v[52:55], v[204:207]
    v_exp_f32 v93, v93
    v_mfma_f32_16x16x32_bf16 v[204:207], a[252:255], v[56:59], v[204:207]
    s_waitcnt lgkmcnt(1)
    v_exp_f32 v94, v94
    s_sub_u32 s62, s62, 1
    s_cmp_lg_u32 s62, 0
    s_cbranch_scc1 L_loop
L_tail:
    v_mfma_f32_16x16x32_bf16 v[68:71], v[96:99], a[0:3], 0
    v_exp_f32 v95, v95
    v_mfma_f32_16x16x32_bf16 v[68:71], v[100:103], a[4:7], v[68:71]
    v_cvt_pk_bf16_f32 v34, v92, v93
    v_cvt_pk_bf16_f32 v35, v94, v95
    v_mfma_f32_16x16x32_bf16 v[68:71], v[104:107], a[8:11], v[68:71]
    s_nop 0
    ds_read_b128 v[52:55], v10 offset:12288
    ds_read_b128 v[56:59], v10 offset:13312
    v_mfma_f32_16x16x32_bf16 v[68:71], v[108:111], a[12:15], v[68:71]
    s_add_u32 m0, s64, 65536
    ds_write_b64 v11, v[34:35] offset:26624
    v_mfma_f32_16x16x32_bf16 v[68:71], v[112:115], a[16:19], v[68:71]
    s_add_u32 s61, s61, 16384
    v_add_f32 v42, v42, v92
    v_add_f32 v42, v42, v93
    v_mfma_f32_16x16x32_bf16 v[68:71], v[116:119], a[20:23], v[68:71]
    buffer_load_dwordx4 v20, s[32:35], s61 offen offset:0 nt lds
    v_mfma_f32_16x16x32_bf16 v[68:71], v[120:123], a[24:27], v[68:71]
    v_add_f32 v42, v42, v94
    v_add_f32 v42, v42, v95
    v_mfma_f32_16x16x32_bf16 v[68:71], v[124:127], a[28:31], v[68:71]
    v_mfma_f32_16x16x32_bf16 v[208:211], a[224:227], v[44:47], v[208:211]
    global_load_dword v7, v5, s[16:17]
    v_mfma_f32_16x16x32_bf16 v[208:211], a[228:231], v[48:51], v[208:211]
    buffer_load_dwordx4 v21, s[32:35], s61 offen offset:1024 nt lds
    v_mfma_f32_16x16x32_bf16 v[212:215], a[232:235], v[44:47], v[212:215]
    v_fma_f32 v68, v68, s3, v240
    v_fma_f32 v69, v69, s3, v240
    v_mfma_f32_16x16x32_bf16 v[212:215], a[236:239], v[48:51], v[212:215]
    v_fma_f32 v70, v70, s3, v240
    v_fma_f32 v71, v71, s3, v240
    v_mfma_f32_16x16x32_bf16 v[216:219], a[240:243], v[44:47], v[216:219]
    buffer_load_dwordx4 v22, s[32:35], s61 offen offset:2048 nt lds
    v_mfma_f32_16x16x32_bf16 v[216:219], a[244:247], v[48:51], v[216:219]
    v_exp_f32 v68, v68
    v_mfma_f32_16x16x32_bf16 v[220:223], a[248:251], v[44:47], v[220:223]
    s_waitcnt lgkmcnt(0)
    v_exp_f32 v69, v69
    v_mfma_f32_16x16x32_bf16 v[220:223], a[252:255], v[48:51], v[220:223]
    s_barrier
    v_exp_f32 v70, v70
    v_mfma_f32_16x16x32_bf16 v[72:75], v[96:99], a[32:35], 0
    v_exp_f32 v71, v71
    v_mfma_f32_16x16x32_bf16 v[72:75], v[100:103], a[36:39], v[72:75]
    v_cvt_pk_bf16_f32 v32, v68, v69
    v_cvt_pk_bf16_f32 v33, v70, v71
    v_mfma_f32_16x16x32_bf16 v[72:75], v[104:107], a[40:43], v[72:75]
    s_nop 0
    ds_read_b128 v[44:47], v10 offset:14336
    ds_read_b128 v[48:51], v10 offset:15360
    v_mfma_f32_16x16x32_bf16 v[72:75], v[108:111], a[44:47], v[72:75]
    ds_write_b64 v11, v[32:33] offset:0
    v_mfma_f32_16x16x32_bf16 v[72:75], v[112:115], a[48:51], v[72:75]
    v_add_f32 v36, v36, v68
    v_add_f32 v36, v36, v69
    v_mfma_f32_16x16x32_bf16 v[72:75], v[116:119], a[52:55], v[72:75]
    buffer_load_dwordx4 v23, s[32:35], s61 offen offset:3072 nt lds
    v_mfma_f32_16x16x32_bf16 v[72:75], v[120:123], a[56:59], v[72:75]
    v_add_f32 v36, v36, v70
    v_add_f32 v36, v36, v71
    v_mfma_f32_16x16x32_bf16 v[72:75], v[124:127], a[60:63], v[72:75]
    v_mfma_f32_16x16x32_bf16 v[224:227], a[224:227], v[52:55], v[224:227]
    s_add_u32 m0, s64, 69632
    s_add_u32 s61, s61, 16384
    v_mfma_f32_16x16x32_bf16 v[224:227], a[228:231], v[56:59], v[224:227]
    buffer_load_dwordx4 v20, s[32:35], s61 offen offset:0 nt lds
    v_mfma_f32_16x16x32_bf16 v[228:231], a[232:235], v[52:55], v[228:231]
    s_waitcnt vmcnt(14)
    ds_read_b64_tr_b16 a[224:225], v12 offset:32768
    v_fma_f32 v72, v72, s3, v241
    v_mfma_f32_16x16x32_bf16 v[228:231], a[236:239], v[56:59], v[228:231]
    s_nop 0
    ds_read_b64_tr_b16 a[226:227], v12 offset:33280
    v_fma_f32 v73, v73, s3, v241
    v_mfma_f32_16x16x32_bf16 v[232:235], a[240:243], v[52:55], v[232:235]
    s_nop 0
    ds_read_b64_tr_b16 a[228:229], v12 offset:33792
    v_fma_f32 v74, v74, s3, v241
    v_mfma_f32_16x16x32_bf16 v[232:235], a[244:247], v[56:59], v[232:235]
    s_nop 0
    ds_read_b64_tr_b16 a[230:231], v12 offset:34304
    v_fma_f32 v75, v75, s3, v241
    v_mfma_f32_16x16x32_bf16 v[236:239], a[248:251], v[52:55], v[236:239]
    v_exp_f32 v72, v72
    v_mfma_f32_16x16x32_bf16 v[236:239], a[252:255], v[56:59], v[236:239]
    v_exp_f32 v73, v73
    v_mfma_f32_16x16x32_bf16 v[76:79], v[96:99], a[64:67], 0
    v_exp_f32 v74, v74
    v_mfma_f32_16x16x32_bf16 v[76:79], v[100:103], a[68:71], v[76:79]
    v_exp_f32 v75, v75
    v_mfma_f32_16x16x32_bf16 v[76:79], v[104:107], a[72:75], v[76:79]
    s_nop 0
    ds_read_b64_tr_b16 a[232:233], v13 offset:32768
    ds_read_b64_tr_b16 a[234:235], v13 offset:33280
    v_mfma_f32_16x16x32_bf16 v[76:79], v[108:111], a[76:79], v[76:79]
    s_nop 0
    ds_read_b64_tr_b16 a[236:237], v13 offset:33792
    ds_read_b64_tr_b16 a[238:239], v13 offset:34304
    v_mfma_f32_16x16x32_bf16 v[76:79], v[112:115], a[80:83], v[76:79]
    s_nop 0
    ds_read_b64_tr_b16 a[240:241], v14 offset:32768
    ds_read_b64_tr_b16 a[242:243], v14 offset:33280
    v_mfma_f32_16x16x32_bf16 v[76:79], v[116:119], a[84:87], v[76:79]
    s_nop 0
    ds_read_b64_tr_b16 a[244:245], v14 offset:33792
    ds_read_b64_tr_b16 a[246:247], v14 offset:34304
    v_mfma_f32_16x16x32_bf16 v[76:79], v[120:123], a[88:91], v[76:79]
    s_nop 0
    ds_read_b64_tr_b16 a[248:249], v15 offset:32768
    ds_read_b64_tr_b16 a[250:251], v15 offset:33280
    v_mfma_f32_16x16x32_bf16 v[76:79], v[124:127], a[92:95], v[76:79]
    s_waitcnt lgkmcnt(10)
    ds_read_b64_tr_b16 a[252:253], v15 offset:33792
    ds_read_b64_tr_b16 a[254:255], v15 offset:34304
    v_mfma_f32_16x16x32_bf16 v[128:131], a[224:227], v[44:47], v[128:131]
    v_cvt_pk_bf16_f32 v34, v72, v73
    v_cvt_pk_bf16_f32 v35, v74, v75
    v_mfma_f32_16x16x32_bf16 v[128:131], a[228:231], v[48:51], v[128:131]
    s_waitcnt lgkmcnt(10)
    ds_read_b128 v[52:55], v10 offset:16384
    ds_read_b128 v[56:59], v10 offset:17408
    v_mfma_f32_16x16x32_bf16 v[132:135], a[232:235], v[44:47], v[132:135]
    s_waitcnt lgkmcnt(10)
    ds_write_b64 v11, v[34:35] offset:2048
    v_mfma_f32_16x16x32_bf16 v[132:135], a[236:239], v[48:51], v[132:135]
    s_waitcnt lgkmcnt(9)
    v_add_f32 v37, v37, v72
    v_add_f32 v37, v37, v73
    v_mfma_f32_16x16x32_bf16 v[136:139], a[240:243], v[44:47], v[136:139]
    s_waitcnt lgkmcnt(7)
    v_add_f32 v37, v37, v74
    v_add_f32 v37, v37, v75
    v_mfma_f32_16x16x32_bf16 v[136:139], a[244:247], v[48:51], v[136:139]
    s_waitcnt lgkmcnt(5)
    v_fma_f32 v76, v76, s3, v242
    v_fma_f32 v77, v77, s3, v242
    v_mfma_f32_16x16x32_bf16 v[140:143], a[248:251], v[44:47], v[140:143]
    s_waitcnt lgkmcnt(3)
    v_fma_f32 v78, v78, s3, v242
    v_fma_f32 v79, v79, s3, v242
    v_mfma_f32_16x16x32_bf16 v[140:143], a[252:255], v[48:51], v[140:143]
    v_exp_f32 v76, v76
    v_mfma_f32_16x16x32_bf16 v[80:83], v[96:99], a[96:99], 0
    v_exp_f32 v77, v77
    v_mfma_f32_16x16x32_bf16 v[80:83], v[100:103], a[100:103], v[80:83]
    v_exp_f32 v78, v78
    v_mfma_f32_16x16x32_bf16 v[80:83], v[104:107], a[104:107], v[80:83]
    v_exp_f32 v79, v79
    v_mfma_f32_16x16x32_bf16 v[80:83], v[108:111], a[108:111], v[80:83]
    v_cvt_pk_bf16_f32 v32, v76, v77
    v_cvt_pk_bf16_f32 v33, v78, v79
    v_mfma_f32_16x16x32_bf16 v[80:83], v[112:115], a[112:115], v[80:83]
    s_nop 0
    ds_read_b128 v[44:47], v10 offset:18432
    ds_read_b128 v[48:51], v10 offset:19456
    v_mfma_f32_16x16x32_bf16 v[80:83], v[116:119], a[116:119], v[80:83]
    ds_write_b64 v11, v[32:33] offset:4096
    v_mfma_f32_16x16x32_bf16 v[80:83], v[120:123], a[120:123], v[80:83]
    v_add_f32 v38, v38, v76
    v_add_f32 v38, v38, v77
    v_mfma_f32_16x16x32_bf16 v[80:83], v[124:127], a[124:127], v[80:83]
    s_waitcnt lgkmcnt(3)
    v_add_f32 v38, v38, v78
    v_add_f32 v38, v38, v79
    v_mfma_f32_16x16x32_bf16 v[144:147], a[224:227], v[52:55], v[144:147]
    buffer_load_dwordx4 v21, s[32:35], s61 offen offset:1024 nt lds
    v_mfma_f32_16x16x32_bf16 v[144:147], a[228:231], v[56:59], v[144:147]
    v_mfma_f32_16x16x32_bf16 v[148:151], a[232:235], v[52:55], v[148:151]
    v_fma_f32 v80, v80, s3, v243
    v_fma_f32 v81, v81, s3, v243
    v_mfma_f32_16x16x32_bf16 v[148:151], a[236:239], v[56:59], v[148:151]
    v_fma_f32 v82, v82, s3, v243
    v_fma_f32 v83, v83, s3, v243
    v_mfma_f32_16x16x32_bf16 v[152:155], a[240:243], v[52:55], v[152:155]
    v_exp_f32 v80, v80
    v_mfma_f32_16x16x32_bf16 v[152:155], a[244:247], v[56:59], v[152:155]
    buffer_load_dwordx4 v22, s[32:35], s61 offen offset:2048 nt lds
    v_mfma_f32_16x16x32_bf16 v[156:159], a[248:251], v[52:55], v[156:159]
    v_exp_f32 v81, v81
    v_mfma_f32_16x16x32_bf16 v[156:159], a[252:255], v[56:59], v[156:159]
    v_exp_f32 v82, v82
    v_mfma_f32_16x16x32_bf16 v[84:87], v[96:99], a[128:131], 0
    v_exp_f32 v83, v83
    v_mfma_f32_16x16x32_bf16 v[84:87], v[100:103], a[132:135], v[84:87]
    v_cvt_pk_bf16_f32 v34, v80, v81
    v_cvt_pk_bf16_f32 v35, v82, v83
    v_mfma_f32_16x16x32_bf16 v[84:87], v[104:107], a[136:139], v[84:87]
    s_nop 0
    ds_read_b128 v[52:55], v10 offset:20480
    ds_read_b128 v[56:59], v10 offset:21504
    v_mfma_f32_16x16x32_bf16 v[84:87], v[108:111], a[140:143], v[84:87]
    ds_write_b64 v11, v[34:35] offset:6144
    v_mfma_f32_16x16x32_bf16 v[84:87], v[112:115], a[144:147], v[84:87]
    v_add_f32 v39, v39, v80
    v_add_f32 v39, v39, v81
    v_mfma_f32_16x16x32_bf16 v[84:87], v[116:119], a[148:151], v[84:87]
    buffer_load_dwordx4 v23, s[32:35], s61 offen offset:3072 nt lds
    v_mfma_f32_16x16x32_bf16 v[84:87], v[120:123], a[152:155], v[84:87]
    v_add_f32 v39, v39, v82
    v_add_f32 v39, v39, v83
    v_mfma_f32_16x16x32_bf16 v[84:87], v[124:127], a[156:159], v[84:87]
    s_waitcnt lgkmcnt(3)
    v_mfma_f32_16x16x32_bf16 v[160:163], a[224:227], v[44:47], v[160:163]
    v_mfma_f32_16x16x32_bf16 v[160:163], a[228:231], v[48:51], v[160:163]
    v_mfma_f32_16x16x32_bf16 v[164:167], a[232:235], v[44:47], v[164:167]
    v_fma_f32 v84, v84, s3, v244
    v_fma_f32 v85, v85, s3, v244
    v_mfma_f32_16x16x32_bf16 v[164:167], a[236:239], v[48:51], v[164:167]
    s_add_u32 m0, s64, 98304
    v_fma_f32 v86, v86, s3, v244
    v_fma_f32 v87, v87, s3, v244
    v_mfma_f32_16x16x32_bf16 v[168:171], a[240:243], v[44:47], v[168:171]
    s_add_u32 s61, s61, 16384
    v_exp_f32 v84, v84
    v_mfma_f32_16x16x32_bf16 v[168:171], a[244:247], v[48:51], v[168:171]
    buffer_load_dwordx4 v20, s[32:35], s61 offen offset:0 nt lds
    v_mfma_f32_16x16x32_bf16 v[172:175], a[248:251], v[44:47], v[172:175]
    v_exp_f32 v85, v85
    v_mfma_f32_16x16x32_bf16 v[172:175], a[252:255], v[48:51], v[172:175]
    v_exp_f32 v86, v86
    v_mfma_f32_16x16x32_bf16 v[88:91], v[96:99], a[160:163], 0
    v_exp_f32 v87, v87
    v_mfma_f32_16x16x32_bf16 v[88:91], v[100:103], a[164:167], v[88:91]
    v_cvt_pk_bf16_f32 v32, v84, v85
    v_cvt_pk_bf16_f32 v33, v86, v87
    v_mfma_f32_16x16x32_bf16 v[88:91], v[104:107], a[168:171], v[88:91]
    s_nop 0
    ds_read_b128 v[44:47], v10 offset:22528
    ds_read_b128 v[48:51], v10 offset:23552
    v_mfma_f32_16x16x32_bf16 v[88:91], v[108:111], a[172:175], v[88:91]
    ds_write_b64 v11, v[32:33] offset:8192
    v_mfma_f32_16x16x32_bf16 v[88:91], v[112:115], a[176:179], v[88:91]
    v_add_f32 v40, v40, v84
    v_add_f32 v40, v40, v85
    v_mfma_f32_16x16x32_bf16 v[88:91], v[116:119], a[180:183], v[88:91]
    buffer_load_dwordx4 v21, s[32:35], s61 offen offset:1024 nt lds
    v_mfma_f32_16x16x32_bf16 v[88:91], v[120:123], a[184:187], v[88:91]
    v_add_f32 v40, v40, v86
    v_add_f32 v40, v40, v87
    v_mfma_f32_16x16x32_bf16 v[88:91], v[124:127], a[188:191], v[88:91]
    s_waitcnt lgkmcnt(3)
    v_mfma_f32_16x16x32_bf16 v[176:179], a[224:227], v[52:55], v[176:179]
    v_mfma_f32_16x16x32_bf16 v[176:179], a[228:231], v[56:59], v[176:179]
    buffer_load_dwordx4 v22, s[32:35], s61 offen offset:2048 nt lds
    v_mfma_f32_16x16x32_bf16 v[180:183], a[232:235], v[52:55], v[180:183]
    v_fma_f32 v88, v88, s3, v245
    v_fma_f32 v89, v89, s3, v245
    v_mfma_f32_16x16x32_bf16 v[180:183], a[236:239], v[56:59], v[180:183]
    v_fma_f32 v90, v90, s3, v245
    v_fma_f32 v91, v91, s3, v245
    v_mfma_f32_16x16x32_bf16 v[184:187], a[240:243], v[52:55], v[184:187]
    v_exp_f32 v88, v88
    v_mfma_f32_16x16x32_bf16 v[184:187], a[244:247], v[56:59], v[184:187]
    v_exp_f32 v89, v89
    v_mfma_f32_16x16x32_bf16 v[188:191], a[248:251], v[52:55], v[188:191]
    v_exp_f32 v90, v90
    v_mfma_f32_16x16x32_bf16 v[188:191], a[252:255], v[56:59], v[188:191]
    v_exp_f32 v91, v91
    v_mfma_f32_16x16x32_bf16 v[92:95], v[96:99], a[192:195], 0
    s_waitcnt vmcnt(12)
    ds_read_b128 v[52:55], v10 offset:24576
    ds_read_b128 v[56:59], v10 offset:25600
    v_mfma_f32_16x16x32_bf16 v[92:95], v[100:103], a[196:199], v[92:95]
    s_nop 0
    ds_read_b128 v[96:99], v16 offset:32768
    v_cvt_pk_bf16_f32 v34, v88, v89
    v_mfma_f32_16x16x32_bf16 v[92:95], v[104:107], a[200:203], v[92:95]
    s_nop 0
    ds_read_b128 v[100:103], v17 offset:32768
    v_cvt_pk_bf16_f32 v35, v90, v91
    v_mfma_f32_16x16x32_bf16 v[92:95], v[108:111], a[204:207], v[92:95]
    s_nop 0
    ds_read_b128 v[104:107], v18 offset:32768
    v_add_f32 v41, v41, v88
    v_mfma_f32_16x16x32_bf16 v[92:95], v[112:115], a[208:211], v[92:95]
    s_nop 0
    ds_read_b128 v[108:111], v19 offset:32768
    v_add_f32 v41, v41, v89
    v_mfma_f32_16x16x32_bf16 v[92:95], v[116:119], a[212:215], v[92:95]
    s_nop 0
    ds_read_b128 v[112:115], v16 offset:33024
    v_add_f32 v41, v41, v90
    v_mfma_f32_16x16x32_bf16 v[92:95], v[120:123], a[216:219], v[92:95]
    s_nop 0
    ds_read_b128 v[116:119], v17 offset:33024
    v_add_f32 v41, v41, v91
    v_mfma_f32_16x16x32_bf16 v[92:95], v[124:127], a[220:223], v[92:95]
    s_waitcnt lgkmcnt(8)
    ds_read_b128 v[120:123], v18 offset:33024
    v_mfma_f32_16x16x32_bf16 v[192:195], a[224:227], v[44:47], v[192:195]
    s_nop 0
    ds_read_b128 v[124:127], v19 offset:33024
    v_mfma_f32_16x16x32_bf16 v[192:195], a[228:231], v[48:51], v[192:195]
    ds_write_b64 v11, v[34:35] offset:10240
    v_mfma_f32_16x16x32_bf16 v[196:199], a[232:235], v[44:47], v[196:199]
    v_fma_f32 v92, v92, s3, v246
    v_fma_f32 v93, v93, s3, v246
    v_mfma_f32_16x16x32_bf16 v[196:199], a[236:239], v[48:51], v[196:199]
    v_fma_f32 v94, v94, s3, v246
    v_fma_f32 v95, v95, s3, v246
    v_mfma_f32_16x16x32_bf16 v[200:203], a[240:243], v[44:47], v[200:203]
    buffer_load_dwordx4 v23, s[32:35], s61 offen offset:3072 nt lds
    v_mfma_f32_16x16x32_bf16 v[200:203], a[244:247], v[48:51], v[200:203]
    v_exp_f32 v92, v92
    v_mfma_f32_16x16x32_bf16 v[204:207], a[248:251], v[44:47], v[204:207]
    v_exp_f32 v93, v93
    v_mfma_f32_16x16x32_bf16 v[204:207], a[252:255], v[48:51], v[204:207]
    s_waitcnt lgkmcnt(1)
    v_exp_f32 v94, v94
    v_mfma_f32_16x16x32_bf16 v[68:71], v[96:99], a[0:3], 0
    v_exp_f32 v95, v95
    v_mfma_f32_16x16x32_bf16 v[68:71], v[100:103], a[4:7], v[68:71]
    v_cvt_pk_bf16_f32 v32, v92, v93
    v_cvt_pk_bf16_f32 v33, v94, v95
    v_mfma_f32_16x16x32_bf16 v[68:71], v[104:107], a[8:11], v[68:71]
    s_nop 0
    ds_read_b128 v[44:47], v10 offset:26624
    ds_read_b128 v[48:51], v10 offset:27648
    v_mfma_f32_16x16x32_bf16 v[68:71], v[108:111], a[12:15], v[68:71]
    s_add_u32 m0, s64, 102400
    ds_write_b64 v11, v[32:33] offset:12288
    v_mfma_f32_16x16x32_bf16 v[68:71], v[112:115], a[16:19], v[68:71]
    s_add_u32 s61, s61, 16384
    v_add_f32 v42, v42, v92
    v_add_f32 v42, v42, v93
    v_mfma_f32_16x16x32_bf16 v[68:71], v[116:119], a[20:23], v[68:71]
    buffer_load_dwordx4 v20, s[32:35], s61 offen offset:0 nt lds
    v_mfma_f32_16x16x32_bf16 v[68:71], v[120:123], a[24:27], v[68:71]
    v_add_f32 v42, v42, v94
    v_add_f32 v42, v42, v95
    v_mfma_f32_16x16x32_bf16 v[68:71], v[124:127], a[28:31], v[68:71]
    v_mfma_f32_16x16x32_bf16 v[208:211], a[224:227], v[52:55], v[208:211]
    v_mfma_f32_16x16x32_bf16 v[208:211], a[228:231], v[56:59], v[208:211]
    buffer_load_dwordx4 v21, s[32:35], s61 offen offset:1024 nt lds
    v_mfma_f32_16x16x32_bf16 v[212:215], a[232:235], v[52:55], v[212:215]
    v_fma_f32 v68, v68, s3, v240
    v_fma_f32 v69, v69, s3, v240
    v_mfma_f32_16x16x32_bf16 v[212:215], a[236:239], v[56:59], v[212:215]
    v_fma_f32 v70, v70, s3, v240
    v_fma_f32 v71, v71, s3, v240
    v_mfma_f32_16x16x32_bf16 v[216:219], a[240:243], v[52:55], v[216:219]
    buffer_load_dwordx4 v22, s[32:35], s61 offen offset:2048 nt lds
    v_mfma_f32_16x16x32_bf16 v[216:219], a[244:247], v[56:59], v[216:219]
    v_exp_f32 v68, v68
    v_mfma_f32_16x16x32_bf16 v[220:223], a[248:251], v[52:55], v[220:223]
    s_waitcnt lgkmcnt(0)
    v_exp_f32 v69, v69
    v_mfma_f32_16x16x32_bf16 v[220:223], a[252:255], v[56:59], v[220:223]
    s_barrier
    v_exp_f32 v70, v70
    v_mfma_f32_16x16x32_bf16 v[72:75], v[96:99], a[32:35], 0
    v_exp_f32 v71, v71
    v_mfma_f32_16x16x32_bf16 v[72:75], v[100:103], a[36:39], v[72:75]
    v_cvt_pk_bf16_f32 v34, v68, v69
    v_cvt_pk_bf16_f32 v35, v70, v71
    v_mfma_f32_16x16x32_bf16 v[72:75], v[104:107], a[40:43], v[72:75]
    s_nop 0
    ds_read_b128 v[52:55], v10 offset:0
    ds_read_b128 v[56:59], v10 offset:1024
    v_mfma_f32_16x16x32_bf16 v[72:75], v[108:111], a[44:47], v[72:75]
    ds_write_b64 v11, v[34:35] offset:14336
    v_mfma_f32_16x16x32_bf16 v[72:75], v[112:115], a[48:51], v[72:75]
    v_add_f32 v36, v36, v68
    v_add_f32 v36, v36, v69
    v_mfma_f32_16x16x32_bf16 v[72:75], v[116:119], a[52:55], v[72:75]
    buffer_load_dwordx4 v23, s[32:35], s61 offen offset:3072 nt lds
    v_mfma_f32_16x16x32_bf16 v[72:75], v[120:123], a[56:59], v[72:75]
    s_add_u32 m0, s64, 0
    s_lshl_b32 s65, s72, 7
    v_add_f32 v36, v36, v70
    v_add_f32 v36, v36, v71
    v_mfma_f32_16x16x32_bf16 v[72:75], v[124:127], a[60:63], v[72:75]
    buffer_load_dwordx4 v60, s[36:39], s65 offen offset:0 lds
    v_mfma_f32_16x16x32_bf16 v[224:227], a[224:227], v[44:47], v[224:227]
    s_waitcnt vmcnt(16)
    v_cmp_eq_u32 vcc, 0, v7
    v_mfma_f32_16x16x32_bf16 v[224:227], a[228:231], v[48:51], v[224:227]
    buffer_load_dwordx4 v61, s[36:39], s65 offen offset:1024 lds
    v_mfma_f32_16x16x32_bf16 v[228:231], a[232:235], v[44:47], v[228:231]
    s_waitcnt vmcnt(10)
    ds_read_b64_tr_b16 a[224:225], v12 offset:0
    v_fma_f32 v72, v72, s3, v241
    v_mfma_f32_16x16x32_bf16 v[228:231], a[236:239], v[48:51], v[228:231]
    s_cbranch_vccnz L_certspin
    L_certok:
    ds_read_b64_tr_b16 a[226:227], v12 offset:512
    v_fma_f32 v73, v73, s3, v241
    v_mfma_f32_16x16x32_bf16 v[232:235], a[240:243], v[44:47], v[232:235]
    s_nop 0
    ds_read_b64_tr_b16 a[228:229], v12 offset:1024
    v_fma_f32 v74, v74, s3, v241
    v_mfma_f32_16x16x32_bf16 v[232:235], a[244:247], v[48:51], v[232:235]
    s_nop 0
    ds_read_b64_tr_b16 a[230:231], v12 offset:1536
    v_fma_f32 v75, v75, s3, v241
    v_mfma_f32_16x16x32_bf16 v[236:239], a[248:251], v[44:47], v[236:239]
    v_exp_f32 v72, v72
    v_mfma_f32_16x16x32_bf16 v[236:239], a[252:255], v[48:51], v[236:239]
    v_exp_f32 v73, v73
    v_mfma_f32_16x16x32_bf16 v[76:79], v[96:99], a[64:67], 0
    v_exp_f32 v74, v74
    v_mfma_f32_16x16x32_bf16 v[76:79], v[100:103], a[68:71], v[76:79]
    v_exp_f32 v75, v75
    v_mfma_f32_16x16x32_bf16 v[76:79], v[104:107], a[72:75], v[76:79]
    s_nop 0
    ds_read_b64_tr_b16 a[232:233], v13 offset:0
    ds_read_b64_tr_b16 a[234:235], v13 offset:512
    v_mfma_f32_16x16x32_bf16 v[76:79], v[108:111], a[76:79], v[76:79]
    s_nop 0
    ds_read_b64_tr_b16 a[236:237], v13 offset:1024
    ds_read_b64_tr_b16 a[238:239], v13 offset:1536
    v_mfma_f32_16x16x32_bf16 v[76:79], v[112:115], a[80:83], v[76:79]
    s_nop 0
    ds_read_b64_tr_b16 a[240:241], v14 offset:0
    ds_read_b64_tr_b16 a[242:243], v14 offset:512
    v_mfma_f32_16x16x32_bf16 v[76:79], v[116:119], a[84:87], v[76:79]
    s_nop 0
    ds_read_b64_tr_b16 a[244:245], v14 offset:1024
    ds_read_b64_tr_b16 a[246:247], v14 offset:1536
    v_mfma_f32_16x16x32_bf16 v[76:79], v[120:123], a[88:91], v[76:79]
    s_nop 0
    ds_read_b64_tr_b16 a[248:249], v15 offset:0
    ds_read_b64_tr_b16 a[250:251], v15 offset:512
    v_mfma_f32_16x16x32_bf16 v[76:79], v[124:127], a[92:95], v[76:79]
    s_waitcnt lgkmcnt(10)
    ds_read_b64_tr_b16 a[252:253], v15 offset:1024
    ds_read_b64_tr_b16 a[254:255], v15 offset:1536
    v_mfma_f32_16x16x32_bf16 v[128:131], a[224:227], v[52:55], v[128:131]
    v_cvt_pk_bf16_f32 v32, v72, v73
    v_cvt_pk_bf16_f32 v33, v74, v75
    v_mfma_f32_16x16x32_bf16 v[128:131], a[228:231], v[56:59], v[128:131]
    s_waitcnt lgkmcnt(10)
    ds_read_b128 v[44:47], v10 offset:2048
    ds_read_b128 v[48:51], v10 offset:3072
    v_mfma_f32_16x16x32_bf16 v[132:135], a[232:235], v[52:55], v[132:135]
    s_waitcnt lgkmcnt(10)
    ds_write_b64 v11, v[32:33] offset:16384
    v_mfma_f32_16x16x32_bf16 v[132:135], a[236:239], v[56:59], v[132:135]
    s_waitcnt lgkmcnt(9)
    v_add_f32 v37, v37, v72
    v_add_f32 v37, v37, v73
    v_mfma_f32_16x16x32_bf16 v[136:139], a[240:243], v[52:55], v[136:139]
    s_waitcnt lgkmcnt(7)
    v_add_f32 v37, v37, v74
    v_add_f32 v37, v37, v75
    v_mfma_f32_16x16x32_bf16 v[136:139], a[244:247], v[56:59], v[136:139]
    s_waitcnt lgkmcnt(5)
    v_fma_f32 v76, v76, s3, v242
    v_fma_f32 v77, v77, s3, v242
    v_mfma_f32_16x16x32_bf16 v[140:143], a[248:251], v[52:55], v[140:143]
    s_waitcnt lgkmcnt(3)
    v_fma_f32 v78, v78, s3, v242
    v_fma_f32 v79, v79, s3, v242
    v_mfma_f32_16x16x32_bf16 v[140:143], a[252:255], v[56:59], v[140:143]
    v_exp_f32 v76, v76
    v_mfma_f32_16x16x32_bf16 v[80:83], v[96:99], a[96:99], 0
    v_exp_f32 v77, v77
    v_mfma_f32_16x16x32_bf16 v[80:83], v[100:103], a[100:103], v[80:83]
    v_exp_f32 v78, v78
    v_mfma_f32_16x16x32_bf16 v[80:83], v[104:107], a[104:107], v[80:83]
    v_exp_f32 v79, v79
    v_mfma_f32_16x16x32_bf16 v[80:83], v[108:111], a[108:111], v[80:83]
    v_cvt_pk_bf16_f32 v34, v76, v77
    v_cvt_pk_bf16_f32 v35, v78, v79
    v_mfma_f32_16x16x32_bf16 v[80:83], v[112:115], a[112:115], v[80:83]
    s_nop 0
    ds_read_b128 v[52:55], v10 offset:4096
    ds_read_b128 v[56:59], v10 offset:5120
    v_mfma_f32_16x16x32_bf16 v[80:83], v[116:119], a[116:119], v[80:83]
    ds_write_b64 v11, v[34:35] offset:18432
    v_mfma_f32_16x16x32_bf16 v[80:83], v[120:123], a[120:123], v[80:83]
    v_add_f32 v38, v38, v76
    v_add_f32 v38, v38, v77
    v_mfma_f32_16x16x32_bf16 v[80:83], v[124:127], a[124:127], v[80:83]
    s_waitcnt lgkmcnt(3)
    v_add_f32 v38, v38, v78
    v_add_f32 v38, v38, v79
    v_mfma_f32_16x16x32_bf16 v[144:147], a[224:227], v[44:47], v[144:147]
    buffer_load_dwordx4 v62, s[36:39], s65 offen offset:2048 lds
    v_mfma_f32_16x16x32_bf16 v[144:147], a[228:231], v[48:51], v[144:147]
    v_readfirstlane_b32 s57, v7
    v_mfma_f32_16x16x32_bf16 v[148:151], a[232:235], v[44:47], v[148:151]
    buffer_load_dwordx4 v63, s[36:39], s65 offen offset:3072 lds
    v_mfma_f32_16x16x32_bf16 v[148:151], a[236:239], v[48:51], v[148:151]
    s_and_b32 s57, s57, 8192
    v_fma_f32 v80, v80, s3, v243
    v_fma_f32 v81, v81, s3, v243
    v_mfma_f32_16x16x32_bf16 v[152:155], a[240:243], v[44:47], v[152:155]
    s_add_u32 m0, s64, 4096
    s_add_u32 s65, s65, 28672
    v_fma_f32 v82, v82, s3, v243
    v_fma_f32 v83, v83, s3, v243
    v_mfma_f32_16x16x32_bf16 v[152:155], a[244:247], v[48:51], v[152:155]
    buffer_load_dwordx4 v60, s[36:39], s65 offen offset:0 lds
    v_mfma_f32_16x16x32_bf16 v[156:159], a[248:251], v[44:47], v[156:159]
    v_exp_f32 v80, v80
    v_mfma_f32_16x16x32_bf16 v[156:159], a[252:255], v[48:51], v[156:159]
    v_exp_f32 v81, v81
    v_mfma_f32_16x16x32_bf16 v[84:87], v[96:99], a[128:131], 0
    v_exp_f32 v82, v82
    v_mfma_f32_16x16x32_bf16 v[84:87], v[100:103], a[132:135], v[84:87]
    v_exp_f32 v83, v83
    v_mfma_f32_16x16x32_bf16 v[84:87], v[104:107], a[136:139], v[84:87]
    s_nop 0
    ds_read_b128 v[44:47], v10 offset:6144
    ds_read_b128 v[48:51], v10 offset:7168
    v_cvt_pk_bf16_f32 v32, v80, v81
    v_cvt_pk_bf16_f32 v33, v82, v83
    v_mfma_f32_16x16x32_bf16 v[84:87], v[108:111], a[140:143], v[84:87]
    ds_write_b64 v11, v[32:33] offset:20480
    v_mfma_f32_16x16x32_bf16 v[84:87], v[112:115], a[144:147], v[84:87]
    v_add_f32 v39, v39, v80
    v_add_f32 v39, v39, v81
    v_mfma_f32_16x16x32_bf16 v[84:87], v[116:119], a[148:151], v[84:87]
    buffer_load_dwordx4 v61, s[36:39], s65 offen offset:1024 lds
    v_mfma_f32_16x16x32_bf16 v[84:87], v[120:123], a[152:155], v[84:87]
    s_waitcnt lgkmcnt(3)
    v_add_f32 v39, v39, v82
    v_add_f32 v39, v39, v83
    v_mfma_f32_16x16x32_bf16 v[84:87], v[124:127], a[156:159], v[84:87]
    buffer_load_dwordx4 v62, s[36:39], s65 offen offset:2048 lds
    v_mfma_f32_16x16x32_bf16 v[160:163], a[224:227], v[52:55], v[160:163]
    v_mfma_f32_16x16x32_bf16 v[160:163], a[228:231], v[56:59], v[160:163]
    buffer_load_dwordx4 v63, s[36:39], s65 offen offset:3072 lds
    v_mfma_f32_16x16x32_bf16 v[164:167], a[232:235], v[52:55], v[164:167]
    v_fma_f32 v84, v84, s3, v244
    v_fma_f32 v85, v85, s3, v244
    v_mfma_f32_16x16x32_bf16 v[164:167], a[236:239], v[56:59], v[164:167]
    s_add_u32 m0, s64, 32768
    v_fma_f32 v86, v86, s3, v244
    v_fma_f32 v87, v87, s3, v244
    v_mfma_f32_16x16x32_bf16 v[168:171], a[240:243], v[52:55], v[168:171]
    s_lshl_b32 s65, s73, 7
    v_exp_f32 v84, v84
    v_mfma_f32_16x16x32_bf16 v[168:171], a[244:247], v[56:59], v[168:171]
    buffer_load_dwordx4 v60, s[36:39], s65 offen offset:0 lds
    v_mfma_f32_16x16x32_bf16 v[172:175], a[248:251], v[52:55], v[172:175]
    v_exp_f32 v85, v85
    v_mfma_f32_16x16x32_bf16 v[172:175], a[252:255], v[56:59], v[172:175]
    v_exp_f32 v86, v86
    v_mfma_f32_16x16x32_bf16 v[88:91], v[96:99], a[160:163], 0
    v_exp_f32 v87, v87
    v_mfma_f32_16x16x32_bf16 v[88:91], v[100:103], a[164:167], v[88:91]
    v_cvt_pk_bf16_f32 v34, v84, v85
    v_cvt_pk_bf16_f32 v35, v86, v87
    v_mfma_f32_16x16x32_bf16 v[88:91], v[104:107], a[168:171], v[88:91]
    s_nop 0
    ds_read_b128 v[52:55], v10 offset:8192
    ds_read_b128 v[56:59], v10 offset:9216
    v_mfma_f32_16x16x32_bf16 v[88:91], v[108:111], a[172:175], v[88:91]
    ds_write_b64 v11, v[34:35] offset:22528
    v_mfma_f32_16x16x32_bf16 v[88:91], v[112:115], a[176:179], v[88:91]
    v_add_f32 v40, v40, v84
    v_add_f32 v40, v40, v85
    v_mfma_f32_16x16x32_bf16 v[88:91], v[116:119], a[180:183], v[88:91]
    buffer_load_dwordx4 v61, s[36:39], s65 offen offset:1024 lds
    v_mfma_f32_16x16x32_bf16 v[88:91], v[120:123], a[184:187], v[88:91]
    s_waitcnt lgkmcnt(3)
    v_add_f32 v40, v40, v86
    v_add_f32 v40, v40, v87
    v_mfma_f32_16x16x32_bf16 v[88:91], v[124:127], a[188:191], v[88:91]
    buffer_load_dwordx4 v62, s[36:39], s65 offen offset:2048 lds
    v_mfma_f32_16x16x32_bf16 v[176:179], a[224:227], v[44:47], v[176:179]
    v_mfma_f32_16x16x32_bf16 v[176:179], a[228:231], v[48:51], v[176:179]
    buffer_load_dwordx4 v63, s[36:39], s65 offen offset:3072 lds
    v_mfma_f32_16x16x32_bf16 v[180:183], a[232:235], v[44:47], v[180:183]
    v_fma_f32 v88, v88, s3, v245
    v_fma_f32 v89, v89, s3, v245
    v_mfma_f32_16x16x32_bf16 v[180:183], a[236:239], v[48:51], v[180:183]
    v_fma_f32 v90, v90, s3, v245
    v_fma_f32 v91, v91, s3, v245
    v_mfma_f32_16x16x32_bf16 v[184:187], a[240:243], v[44:47], v[184:187]
    v_exp_f32 v88, v88
    v_mfma_f32_16x16x32_bf16 v[184:187], a[244:247], v[48:51], v[184:187]
    s_barrier
    v_exp_f32 v89, v89
    v_mfma_f32_16x16x32_bf16 v[188:191], a[248:251], v[44:47], v[188:191]
    v_exp_f32 v90, v90
    v_mfma_f32_16x16x32_bf16 v[188:191], a[252:255], v[48:51], v[188:191]
    v_exp_f32 v91, v91
    v_mfma_f32_16x16x32_bf16 v[92:95], v[96:99], a[192:195], 0
    s_nop 0
    ds_read_b128 v[44:47], v10 offset:10240
    ds_read_b128 v[48:51], v10 offset:11264
    v_mfma_f32_16x16x32_bf16 v[92:95], v[100:103], a[196:199], v[92:95]
    s_waitcnt vmcnt(12)
    v_cvt_pk_bf16_f32 v32, v88, v89
    v_cvt_pk_bf16_f32 v33, v90, v91
    v_mfma_f32_16x16x32_bf16 v[92:95], v[104:107], a[200:203], v[92:95]
    s_nop 0
    ds_read_b64_tr_b16 v[96:97], v12 offset:32768
    ds_read_b64_tr_b16 v[98:99], v12 offset:33280
    v_mfma_f32_16x16x32_bf16 v[92:95], v[108:111], a[204:207], v[92:95]
    s_nop 0
    ds_read_b64_tr_b16 v[100:101], v12 offset:33792
    ds_read_b64_tr_b16 v[102:103], v12 offset:34304
    v_mfma_f32_16x16x32_bf16 v[92:95], v[112:115], a[208:211], v[92:95]
    s_nop 0
    ds_read_b64_tr_b16 v[104:105], v13 offset:32768
    ds_read_b64_tr_b16 v[106:107], v13 offset:33280
    v_mfma_f32_16x16x32_bf16 v[92:95], v[116:119], a[212:215], v[92:95]
    s_nop 0
    ds_read_b64_tr_b16 v[108:109], v13 offset:33792
    ds_read_b64_tr_b16 v[110:111], v13 offset:34304
    v_mfma_f32_16x16x32_bf16 v[92:95], v[120:123], a[216:219], v[92:95]
    s_nop 0
    ds_read_b64_tr_b16 v[112:113], v14 offset:32768
    ds_read_b64_tr_b16 v[114:115], v14 offset:33280
    v_mfma_f32_16x16x32_bf16 v[92:95], v[124:127], a[220:223], v[92:95]
    s_waitcnt lgkmcnt(12)
    ds_read_b64_tr_b16 v[116:117], v14 offset:33792
    ds_read_b64_tr_b16 v[118:119], v14 offset:34304
    v_mfma_f32_16x16x32_bf16 v[192:195], a[224:227], v[52:55], v[192:195]
    s_nop 0
    ds_read_b64_tr_b16 v[120:121], v15 offset:32768
    ds_read_b64_tr_b16 v[122:123], v15 offset:33280
    v_mfma_f32_16x16x32_bf16 v[192:195], a[228:231], v[56:59], v[192:195]
    s_nop 0
    ds_read_b64_tr_b16 v[124:125], v15 offset:33792
    ds_read_b64_tr_b16 v[126:127], v15 offset:34304
    v_mfma_f32_16x16x32_bf16 v[196:199], a[232:235], v[52:55], v[196:199]
    v_fma_f32 v92, v92, s3, v246
    v_fma_f32 v93, v93, s3, v246
    v_mfma_f32_16x16x32_bf16 v[196:199], a[236:239], v[56:59], v[196:199]
    v_fma_f32 v94, v94, s3, v246
    v_fma_f32 v95, v95, s3, v246
    v_mfma_f32_16x16x32_bf16 v[200:203], a[240:243], v[52:55], v[200:203]
    v_exp_f32 v92, v92
    v_mfma_f32_16x16x32_bf16 v[200:203], a[244:247], v[56:59], v[200:203]
    v_exp_f32 v93, v93
    v_mfma_f32_16x16x32_bf16 v[204:207], a[248:251], v[52:55], v[204:207]
    v_exp_f32 v94, v94
    v_mfma_f32_16x16x32_bf16 v[204:207], a[252:255], v[56:59], v[204:207]
    s_waitcnt lgkmcnt(4)
    v_exp_f32 v95, v95
    v_mfma_f32_16x16x32_bf16 v[208:211], a[224:227], v[44:47], v[208:211]
    s_nop 0
    ds_read_b128 v[52:55], v10 offset:12288
    ds_read_b128 v[56:59], v10 offset:13312
    v_mfma_f32_16x16x32_bf16 v[208:211], a[228:231], v[48:51], v[208:211]
    v_cvt_pk_bf16_f32 v34, v92, v93
    v_cvt_pk_bf16_f32 v35, v94, v95
    v_mfma_f32_16x16x32_bf16 v[212:215], a[232:235], v[44:47], v[212:215]
    s_nop 0
    ds_read_b128 v[68:71], v10 offset:14336
    ds_read_b128 v[72:75], v10 offset:15360
    v_mfma_f32_16x16x32_bf16 v[212:215], a[236:239], v[48:51], v[212:215]
    s_nop 0
    ds_read_b128 v[76:79], v10 offset:16384
    ds_read_b128 v[80:83], v10 offset:17408
    v_mfma_f32_16x16x32_bf16 v[216:219], a[240:243], v[44:47], v[216:219]
    ds_write_b64 v11, v[32:33] offset:24576
    v_mfma_f32_16x16x32_bf16 v[216:219], a[244:247], v[48:51], v[216:219]
    s_add_u32 m0, s64, 36864
    ds_write_b64 v11, v[34:35] offset:26624
    v_mfma_f32_16x16x32_bf16 v[220:223], a[248:251], v[44:47], v[220:223]
    s_add_u32 s65, s65, 28672
    v_add_f32 v42, v42, v92
    v_add_f32 v42, v42, v93
    v_mfma_f32_16x16x32_bf16 v[220:223], a[252:255], v[48:51], v[220:223]
    buffer_load_dwordx4 v60, s[36:39], s65 offen offset:0 lds
    s_waitcnt lgkmcnt(7)
    v_mfma_f32_16x16x32_bf16 v[224:227], a[224:227], v[52:55], v[224:227]
    s_waitcnt lgkmcnt(6)
    v_add_f32 v42, v42, v94
    v_add_f32 v42, v42, v95
    v_mfma_f32_16x16x32_bf16 v[224:227], a[228:231], v[56:59], v[224:227]
    buffer_load_dwordx4 v61, s[36:39], s65 offen offset:1024 lds
    v_mfma_f32_16x16x32_bf16 v[228:231], a[232:235], v[52:55], v[228:231]
    v_add_f32 v41, v41, v88
    v_add_f32 v41, v41, v89
    v_mfma_f32_16x16x32_bf16 v[228:231], a[236:239], v[56:59], v[228:231]
    buffer_load_dwordx4 v62, s[36:39], s65 offen offset:2048 lds
    v_mfma_f32_16x16x32_bf16 v[232:235], a[240:243], v[52:55], v[232:235]
    v_add_f32 v41, v41, v90
    v_add_f32 v41, v41, v91
    v_mfma_f32_16x16x32_bf16 v[232:235], a[244:247], v[56:59], v[232:235]
    s_waitcnt vmcnt(7) lgkmcnt(0)
    buffer_load_dwordx4 v63, s[36:39], s65 offen offset:3072 lds
    v_mfma_f32_16x16x32_bf16 v[236:239], a[248:251], v[52:55], v[236:239]
    s_barrier
    v_permlane32_swap_b32 v36, v38
    v_permlane32_swap_b32 v40, v42
    v_mfma_f32_16x16x32_bf16 v[236:239], a[252:255], v[56:59], v[236:239]
    v_permlane32_swap_b32 v37, v39
    v_permlane32_swap_b32 v41, v43
    v_mfma_f32_16x16x32_bf16 v[128:131], v[96:99], v[68:71], v[128:131]
    v_add_f32 v36, v36, v38
    v_add_f32 v40, v40, v42
    v_mfma_f32_16x16x32_bf16 v[128:131], v[100:103], v[72:75], v[128:131]
    v_add_f32 v37, v37, v39
    v_add_f32 v41, v41, v43
    v_mfma_f32_16x16x32_bf16 v[132:135], v[104:107], v[68:71], v[132:135]
    s_nop 0
    ds_read_b128 v[84:87], v10 offset:18432
    ds_read_b128 v[88:91], v10 offset:19456
    v_mfma_f32_16x16x32_bf16 v[132:135], v[108:111], v[72:75], v[132:135]
    v_permlane16_swap_b32 v36, v40
    v_permlane16_swap_b32 v37, v41
    v_mfma_f32_16x16x32_bf16 v[136:139], v[112:115], v[68:71], v[136:139]
    v_cvt_pk_bf16_f32 v128, v128, v129
    v_cvt_pk_bf16_f32 v129, v130, v131
    v_mfma_f32_16x16x32_bf16 v[136:139], v[116:119], v[72:75], v[136:139]
    v_add_f32 v36, v36, v40
    v_add_f32 v37, v37, v41
    v_mfma_f32_16x16x32_bf16 v[140:143], v[120:123], v[68:71], v[140:143]
    v_cvt_pk_bf16_f32 v130, v132, v133
    v_cvt_pk_bf16_f32 v131, v134, v135
    v_mfma_f32_16x16x32_bf16 v[140:143], v[124:127], v[72:75], v[140:143]
    s_nop 0
    ds_read_b64_tr_b16 a[160:161], v250 offset:0
    ds_read_b64_tr_b16 a[162:163], v250 offset:2048
    v_mfma_f32_16x16x32_bf16 v[144:147], v[96:99], v[76:79], v[144:147]
    v_cvt_pk_bf16_f32 v136, v136, v137
    v_cvt_pk_bf16_f32 v137, v138, v139
    v_mfma_f32_16x16x32_bf16 v[144:147], v[100:103], v[80:83], v[144:147]
    s_nop 0
    ds_read_b128 v[68:71], v10 offset:20480
    ds_read_b128 v[72:75], v10 offset:21504
    v_mfma_f32_16x16x32_bf16 v[148:151], v[104:107], v[76:79], v[148:151]
    v_cvt_pk_bf16_f32 v138, v140, v141
    v_cvt_pk_bf16_f32 v139, v142, v143
    v_mfma_f32_16x16x32_bf16 v[148:151], v[108:111], v[80:83], v[148:151]
    ds_write_b128 v254, v[128:131] offset:0
    v_mfma_f32_16x16x32_bf16 v[152:155], v[112:115], v[76:79], v[152:155]
    ds_write_b128 v254, v[136:139] offset:1024
    v_mfma_f32_16x16x32_bf16 v[152:155], v[116:119], v[80:83], v[152:155]
    s_add_u32 m0, s64, 65536
    ds_write_b64 v253, v[36:37]
    v_mfma_f32_16x16x32_bf16 v[156:159], v[120:123], v[76:79], v[156:159]
    s_lshl_b32 s65, s74, 7
    ds_read_b64_tr_b16 a[164:165], v250 offset:4096
    ds_read_b64_tr_b16 a[166:167], v250 offset:6144
    v_mfma_f32_16x16x32_bf16 v[156:159], v[124:127], v[80:83], v[156:159]
    buffer_load_dwordx4 v60, s[36:39], s65 offen offset:0 lds
    s_waitcnt lgkmcnt(7)
    v_mfma_f32_16x16x32_bf16 v[160:163], v[96:99], v[84:87], v[160:163]
    v_cvt_pk_bf16_f32 v144, v144, v145
    v_cvt_pk_bf16_f32 v152, v152, v153
    v_mfma_f32_16x16x32_bf16 v[160:163], v[100:103], v[88:91], v[160:163]
    v_cvt_pk_bf16_f32 v145, v146, v147
    v_cvt_pk_bf16_f32 v153, v154, v155
    v_mfma_f32_16x16x32_bf16 v[164:167], v[104:107], v[84:87], v[164:167]
    v_cvt_pk_bf16_f32 v146, v148, v149
    v_cvt_pk_bf16_f32 v154, v156, v157
    v_mfma_f32_16x16x32_bf16 v[164:167], v[108:111], v[88:91], v[164:167]
    v_cvt_pk_bf16_f32 v147, v150, v151
    v_cvt_pk_bf16_f32 v155, v158, v159
    v_mfma_f32_16x16x32_bf16 v[168:171], v[112:115], v[84:87], v[168:171]
    v_cvt_pk_bf16_f32 v160, v160, v161
    v_cvt_pk_bf16_f32 v161, v162, v163
    v_mfma_f32_16x16x32_bf16 v[168:171], v[116:119], v[88:91], v[168:171]
    buffer_load_dwordx4 v61, s[36:39], s65 offen offset:1024 lds
    v_mfma_f32_16x16x32_bf16 v[172:175], v[120:123], v[84:87], v[172:175]
    s_waitcnt vmcnt(2) lgkmcnt(2)
    ds_read_b64_tr_b16 a[168:169], v250 offset:8192
    ds_read_b64_tr_b16 a[170:171], v250 offset:10240
    v_mfma_f32_16x16x32_bf16 v[172:175], v[124:127], v[88:91], v[172:175]
    s_barrier
    ds_read_b128 a[0:3], v255 offset:0
    ds_read_b128 a[4:7], v255 offset:1024
    v_mfma_f32_16x16x32_bf16 v[176:179], v[96:99], v[68:71], v[176:179]
    s_nop 0
    ds_read_b128 a[8:11], v255 offset:2048
    ds_read_b64_tr_b16 a[172:173], v250 offset:12288
    v_mfma_f32_16x16x32_bf16 v[176:179], v[100:103], v[72:75], v[176:179]
    s_nop 0
    ds_read_b64_tr_b16 a[174:175], v250 offset:14336
    ds_read_b64_tr_b16 a[176:177], v250 offset:16384
    v_mfma_f32_16x16x32_bf16 v[180:183], v[104:107], v[68:71], v[180:183]
    s_nop 0
    ds_read_b128 a[12:15], v255 offset:3072
    v_cvt_pk_bf16_f32 v168, v168, v169
    v_mfma_f32_16x16x32_bf16 v[180:183], v[108:111], v[72:75], v[180:183]
    buffer_load_dwordx4 v62, s[36:39], s65 offen offset:2048 lds
    v_mfma_f32_16x16x32_bf16 v[184:187], v[112:115], v[68:71], v[184:187]
    s_nop 0
    ds_read_b64_tr_b16 a[178:179], v250 offset:18432
    ds_read_b128 a[16:19], v255 offset:4096
    v_mfma_f32_16x16x32_bf16 v[184:187], v[116:119], v[72:75], v[184:187]
    s_nop 0
    ds_read_b64_tr_b16 a[180:181], v250 offset:20480
    ds_read_b64_tr_b16 a[182:183], v250 offset:22528
    v_mfma_f32_16x16x32_bf16 v[188:191], v[120:123], v[68:71], v[188:191]
    s_nop 0
    ds_read_b128 a[20:23], v255 offset:5120
    ds_read_b64_tr_b16 a[184:185], v250 offset:24576
    v_mfma_f32_16x16x32_bf16 v[188:191], v[124:127], v[72:75], v[188:191]
    s_waitcnt lgkmcnt(11)
    ds_read_b64_tr_b16 a[186:187], v250 offset:26624
    ds_read_b64_tr_b16 a[188:189], v250 offset:28672
    v_mfma_f32_16x16x32_bf16 v[52:55], a[160:163], a[0:3], 0
    s_waitcnt lgkmcnt(11)
    ds_read_b128 a[24:27], v255 offset:6144
    v_cvt_pk_bf16_f32 v169, v170, v171
    v_mfma_f32_16x16x32_bf16 v[52:55], a[164:167], a[4:7], v[52:55]
    buffer_load_dwordx4 v63, s[36:39], s65 offen offset:3072 lds
    ds_read_b64_tr_b16 a[190:191], v250 offset:30720
    ds_read_b128 a[28:31], v255 offset:7168
    v_mfma_f32_16x16x32_bf16 v[52:55], a[168:171], a[8:11], v[52:55]
    s_waitcnt lgkmcnt(11)
    ds_read_b64_tr_b16 a[192:193], v250 offset:32768
    ds_read_b64_tr_b16 a[194:195], v250 offset:34816
    v_mfma_f32_16x16x32_bf16 v[52:55], a[172:175], a[12:15], v[52:55]
    s_waitcnt lgkmcnt(11)
    ds_read_b64_tr_b16 a[196:197], v250 offset:36864
    ds_read_b64_tr_b16 a[198:199], v250 offset:38912
    v_cvt_pk_bf16_f32 v162, v164, v165
    v_cvt_pk_bf16_f32 v170, v172, v173
    v_cvt_pk_bf16_f32 v163, v166, v167
    v_cvt_pk_bf16_f32 v171, v174, v175
    v_mfma_f32_16x16x32_bf16 v[52:55], a[176:179], a[16:19], v[52:55]
    s_waitcnt lgkmcnt(4)
    ds_read_b64_tr_b16 a[200:201], v250 offset:40960
    ds_write_b128 v254, v[144:147] offset:8192
    ds_read_b64_tr_b16 a[202:203], v250 offset:43008
    v_mfma_f32_16x16x32_bf16 v[52:55], a[180:183], a[20:23], v[52:55]
    s_add_u32 m0, s64, 69632
    ds_read_b64_tr_b16 a[204:205], v250 offset:45056
    ds_write_b128 v254, v[152:155] offset:9216
    ds_read_b64_tr_b16 a[206:207], v250 offset:47104
    v_mfma_f32_16x16x32_bf16 v[52:55], a[184:187], a[24:27], v[52:55]
    s_add_u32 s65, s65, 28672
    ds_read_b64_tr_b16 a[208:209], v250 offset:49152
    ds_write_b128 v254, v[160:163] offset:16384
    ds_read_b64_tr_b16 a[210:211], v250 offset:51200
    v_mfma_f32_16x16x32_bf16 v[52:55], a[188:191], a[28:31], v[52:55]
    buffer_load_dwordx4 v60, s[36:39], s65 offen offset:0 lds
    ds_read_b64_tr_b16 a[212:213], v250 offset:53248
    ds_read_b64_tr_b16 a[214:215], v250 offset:55296
    s_waitcnt lgkmcnt(13)
    v_mfma_f32_16x16x32_bf16 v[56:59], a[192:195], a[0:3], 0
    s_waitcnt lgkmcnt(11)
    ds_write_b128 v254, v[168:171] offset:17408
    ds_read_b64_tr_b16 a[216:217], v250 offset:57344
    ds_read_b64_tr_b16 a[218:219], v250 offset:59392
    v_mfma_f32_16x16x32_bf16 v[56:59], a[196:199], a[4:7], v[56:59]
    s_waitcnt lgkmcnt(11)
    ds_read_b64_tr_b16 a[220:221], v250 offset:61440
    ds_read_b128 v[76:79], v10 offset:22528
    ds_read_b64_tr_b16 a[222:223], v250 offset:63488
    v_mfma_f32_16x16x32_bf16 v[56:59], a[200:203], a[8:11], v[56:59]
    s_waitcnt lgkmcnt(11)
    ds_read_b128 v[80:83], v10 offset:23552
    v_cvt_pk_bf16_f32 v176, v176, v177
    v_mfma_f32_16x16x32_bf16 v[56:59], a[204:207], a[12:15], v[56:59]
    s_waitcnt lgkmcnt(9)
    v_cvt_pk_bf16_f32 v184, v184, v185
    v_cvt_pk_bf16_f32 v177, v178, v179
    v_mfma_f32_16x16x32_bf16 v[56:59], a[208:211], a[16:19], v[56:59]
    s_waitcnt lgkmcnt(4)
    v_cvt_pk_bf16_f32 v185, v186, v187
    v_cvt_pk_bf16_f32 v178, v180, v181
    v_mfma_f32_16x16x32_bf16 v[56:59], a[212:215], a[20:23], v[56:59]
    buffer_load_dwordx4 v61, s[36:39], s65 offen offset:1024 lds
    v_mfma_f32_16x16x32_bf16 v[56:59], a[216:219], a[24:27], v[56:59]
    s_waitcnt lgkmcnt(1)
    v_cvt_pk_bf16_f32 v186, v188, v189
    v_cvt_pk_bf16_f32 v179, v182, v183
    v_mfma_f32_16x16x32_bf16 v[56:59], a[220:223], a[28:31], v[56:59]
    v_cvt_pk_bf16_f32 v187, v190, v191
    v_mfma_f32_16x16x32_bf16 v[192:195], v[96:99], v[76:79], v[192:195]
    s_waitcnt lgkmcnt(0)
    v_mfma_f32_16x16x32_bf16 v[192:195], v[100:103], v[80:83], v[192:195]
    s_nop 0
    ds_read_b64 v[44:45], v66 offset:0
    ds_read_b64 v[46:47], v66 offset:512
    v_mfma_f32_16x16x32_bf16 v[196:199], v[104:107], v[76:79], v[196:199]
    s_barrier
    ds_read_b128 a[32:35], v255 offset:8192
    ds_read_b64 v[48:49], v66 offset:1024
    v_mfma_f32_16x16x32_bf16 v[196:199], v[108:111], v[80:83], v[196:199]
    buffer_load_dwordx4 v62, s[36:39], s65 offen offset:2048 lds
    ds_read_b128 a[36:39], v255 offset:9216
    v_mfma_f32_16x16x32_bf16 v[200:203], v[112:115], v[76:79], v[200:203]
    s_nop 0
    ds_read_b64 v[50:51], v66 offset:1536
    ds_read_b128 a[40:43], v255 offset:10240
    v_mfma_f32_16x16x32_bf16 v[200:203], v[116:119], v[80:83], v[200:203]
    s_nop 0
    ds_read_b128 a[44:47], v255 offset:11264
    v_cvt_pk_bf16_f32 v192, v192, v193
    v_mfma_f32_16x16x32_bf16 v[204:207], v[120:123], v[76:79], v[204:207]
    s_nop 0
    ds_read_b128 a[48:51], v255 offset:12288
    v_cvt_pk_bf16_f32 v193, v194, v195
    v_mfma_f32_16x16x32_bf16 v[204:207], v[124:127], v[80:83], v[204:207]
    s_waitcnt lgkmcnt(6)
    ds_read_b128 a[52:55], v255 offset:13312
    v_cvt_pk_bf16_f32 v194, v196, v197
    v_mfma_f32_16x16x32_bf16 v[92:95], a[160:163], a[32:35], 0
    s_waitcnt lgkmcnt(3)
    ds_read_b128 a[56:59], v255 offset:14336
    v_cvt_pk_bf16_f32 v200, v200, v201
    v_mfma_f32_16x16x32_bf16 v[92:95], a[164:167], a[36:39], v[92:95]
    buffer_load_dwordx4 v63, s[36:39], s65 offen offset:3072 lds
    ds_read_b128 a[60:63], v255 offset:15360
    v_mfma_f32_16x16x32_bf16 v[92:95], a[168:171], a[40:43], v[92:95]
    s_waitcnt lgkmcnt(4)
    v_add_f32 v44, v44, v46
    v_add_f32 v45, v45, v47
    v_add_f32 v48, v48, v50
    v_add_f32 v49, v49, v51
    v_add_f32 v44, v44, v48
    v_mfma_f32_16x16x32_bf16 v[92:95], a[172:175], a[44:47], v[92:95]
    s_waitcnt lgkmcnt(3)
    ds_read_b128 v[84:87], v10 offset:24576
    v_add_f32 v45, v45, v49
    v_mfma_f32_16x16x32_bf16 v[92:95], a[176:179], a[48:51], v[92:95]
    s_waitcnt lgkmcnt(1)
    v_rcp_f32 v36, v44
    v_mfma_f32_16x16x32_bf16 v[92:95], a[180:183], a[52:55], v[92:95]
    s_add_u32 m0, s64, 0
    v_rcp_f32 v37, v45
    v_mfma_f32_16x16x32_bf16 v[92:95], a[184:187], a[56:59], v[92:95]
    s_lshl_b32 s65, s75, 7
    v_mov_b32 v40, v36
    v_mov_b32 v41, v37
    v_mfma_f32_16x16x32_bf16 v[92:95], a[188:191], a[60:63], v[92:95]
    buffer_load_dwordx4 v60, s[36:39], s65 offen offset:0 lds
    v_mfma_f32_16x16x32_bf16 v[240:243], a[192:195], a[32:35], 0
    v_permlane16_swap_b32 v36, v40
    v_permlane16_swap_b32 v37, v41
    v_mfma_f32_16x16x32_bf16 v[240:243], a[196:199], a[36:39], v[240:243]
    v_mov_b32 v38, v36
    v_mov_b32 v39, v37
    v_mfma_f32_16x16x32_bf16 v[240:243], a[200:203], a[40:43], v[240:243]
    s_cmp_eq_u32 s71, 0
    s_cselect_b32 s42, 0, s69
    ds_read_b128 v[88:91], v10 offset:25600
    v_mov_b32 v42, v40
    v_mfma_f32_16x16x32_bf16 v[240:243], a[204:207], a[44:47], v[240:243]
    s_nop 0
    ds_read_b128 a[64:67], v255 offset:16384
    v_mov_b32 v43, v41
    v_mfma_f32_16x16x32_bf16 v[240:243], a[208:211], a[48:51], v[240:243]
    s_xor_b32 s63, s57, 0
    ds_read_b128 a[68:71], v255 offset:17408
    ds_read_b128 a[72:75], v255 offset:18432
    v_mfma_f32_16x16x32_bf16 v[240:243], a[212:215], a[52:55], v[240:243]
    buffer_load_dwordx4 v61, s[36:39], s65 offen offset:1024 lds
    v_mfma_f32_16x16x32_bf16 v[240:243], a[216:219], a[56:59], v[240:243]
    v_permlane32_swap_b32 v36, v38
    v_permlane32_swap_b32 v37, v39
    v_permlane32_swap_b32 v40, v42
    v_permlane32_swap_b32 v41, v43
    v_mfma_f32_16x16x32_bf16 v[240:243], a[220:223], a[60:63], v[240:243]
    s_waitcnt lgkmcnt(4)
    v_mul_f32 v52, v36, v52
    v_mul_f32 v56, v36, v56
    v_mul_f32 v53, v36, v53
    v_mul_f32 v57, v36, v57
    v_mfma_f32_16x16x32_bf16 v[208:211], v[96:99], v[84:87], v[208:211]
    s_waitcnt lgkmcnt(3)
    v_mul_f32 v54, v36, v54
    v_mul_f32 v58, v36, v58
    v_mul_f32 v55, v36, v55
    v_mul_f32 v59, v36, v59
    v_mfma_f32_16x16x32_bf16 v[208:211], v[100:103], v[88:91], v[208:211]
    v_cvt_pk_bf16_f32 v64, v52, v53
    v_cvt_pk_bf16_f32 v66, v56, v57
    v_cvt_pk_bf16_f32 v65, v54, v55
    v_cvt_pk_bf16_f32 v67, v58, v59
    v_mfma_f32_16x16x32_bf16 v[212:215], v[104:107], v[84:87], v[212:215]
    buffer_store_dwordx4 v[64:67], v248, s[40:43], s63 offen sc1
    v_mfma_f32_16x16x32_bf16 v[212:215], v[108:111], v[88:91], v[212:215]
    s_cmp_eq_u32 s42, 0
    s_cbranch_scc1 L_own0
    L_ownb0:
    ds_read_b128 a[76:79], v255 offset:19456
    ds_read_b128 a[80:83], v255 offset:20480
    v_mfma_f32_16x16x32_bf16 v[216:219], v[112:115], v[84:87], v[216:219]
    buffer_load_dwordx4 v62, s[36:39], s65 offen offset:2048 lds
    v_mfma_f32_16x16x32_bf16 v[216:219], v[116:119], v[88:91], v[216:219]
    s_nop 0
    ds_read_b128 a[84:87], v255 offset:21504
    ds_read_b128 a[88:91], v255 offset:22528
    v_mfma_f32_16x16x32_bf16 v[220:223], v[120:123], v[84:87], v[220:223]
    s_nop 0
    ds_read_b128 a[92:95], v255 offset:23552
    v_cvt_pk_bf16_f32 v201, v202, v203
    v_mfma_f32_16x16x32_bf16 v[220:223], v[124:127], v[88:91], v[220:223]
    s_waitcnt lgkmcnt(5)
    v_cvt_pk_bf16_f32 v202, v204, v205
    v_cvt_pk_bf16_f32 v195, v198, v199
    v_mfma_f32_16x16x32_bf16 v[244:247], a[160:163], a[64:67], 0
    s_nop 0
    ds_read_b128 v[68:71], v10 offset:26624
    v_cvt_pk_bf16_f32 v203, v206, v207
    v_mfma_f32_16x16x32_bf16 v[244:247], a[164:167], a[68:71], v[244:247]
    buffer_load_dwordx4 v63, s[36:39], s65 offen offset:3072 lds
    v_mfma_f32_16x16x32_bf16 v[244:247], a[168:171], a[72:75], v[244:247]
    s_waitcnt lgkmcnt(5)
    ds_write_b128 v254, v[176:179] offset:24576
    v_mfma_f32_16x16x32_bf16 v[244:247], a[172:175], a[76:79], v[244:247]
    s_waitcnt lgkmcnt(3)
    ds_write_b128 v254, v[184:187] offset:25600
    v_mfma_f32_16x16x32_bf16 v[244:247], a[176:179], a[80:83], v[244:247]
    s_add_u32 m0, s64, 4096
    ds_write_b128 v254, v[192:195] offset:32768
    v_mfma_f32_16x16x32_bf16 v[244:247], a[180:183], a[84:87], v[244:247]
    s_add_u32 s65, s65, 28672
    ds_write_b128 v254, v[200:203] offset:33792
    v_mfma_f32_16x16x32_bf16 v[244:247], a[184:187], a[88:91], v[244:247]
    s_cmp_eq_u32 s71, 1
    s_cselect_b32 s42, 0, s69
    ds_read_b128 v[72:75], v10 offset:27648
    v_mul_f32 v92, v37, v92
    s_waitcnt lgkmcnt(6)
    v_mfma_f32_16x16x32_bf16 v[244:247], a[188:191], a[92:95], v[244:247]
    buffer_load_dwordx4 v60, s[36:39], s65 offen offset:0 lds
    v_mfma_f32_16x16x32_bf16 v[52:55], a[192:195], a[64:67], 0
    s_xor_b32 s63, s57, 2105344
    v_mul_f32 v240, v37, v240
    v_mul_f32 v93, v37, v93
    v_mfma_f32_16x16x32_bf16 v[52:55], a[196:199], a[68:71], v[52:55]
    v_mul_f32 v241, v37, v241
    v_mul_f32 v94, v37, v94
    v_mfma_f32_16x16x32_bf16 v[52:55], a[200:203], a[72:75], v[52:55]
    v_mul_f32 v242, v37, v242
    v_mul_f32 v95, v37, v95
    v_mfma_f32_16x16x32_bf16 v[52:55], a[204:207], a[76:79], v[52:55]
    v_mul_f32 v243, v37, v243
    v_cvt_pk_bf16_f32 v32, v92, v93
    v_mfma_f32_16x16x32_bf16 v[52:55], a[208:211], a[80:83], v[52:55]
    v_cvt_pk_bf16_f32 v34, v240, v241
    v_cvt_pk_bf16_f32 v33, v94, v95
    v_mfma_f32_16x16x32_bf16 v[52:55], a[212:215], a[84:87], v[52:55]
    s_waitcnt lgkmcnt(1)
    v_cvt_pk_bf16_f32 v35, v242, v243
    v_mul_f32 v244, v38, v244
    v_mfma_f32_16x16x32_bf16 v[52:55], a[216:219], a[88:91], v[52:55]
    buffer_store_dwordx4 v[32:35], v248, s[40:43], s63 offen sc1
    v_mfma_f32_16x16x32_bf16 v[52:55], a[220:223], a[92:95], v[52:55]
    s_cmp_eq_u32 s42, 0
    s_cbranch_scc1 L_own1
    L_ownb1:
    v_mul_f32 v245, v38, v245
    v_mul_f32 v246, v38, v246
    v_mfma_f32_16x16x32_bf16 v[224:227], v[96:99], v[68:71], v[224:227]
    buffer_load_dwordx4 v61, s[36:39], s65 offen offset:1024 lds
    s_waitcnt lgkmcnt(0)
    v_mfma_f32_16x16x32_bf16 v[224:227], v[100:103], v[72:75], v[224:227]
    s_barrier
    ds_read_b128 a[96:99], v255 offset:24576
    ds_read_b128 a[100:103], v255 offset:25600
    v_mfma_f32_16x16x32_bf16 v[228:231], v[104:107], v[68:71], v[228:231]
    s_nop 0
    ds_read_b128 a[104:107], v255 offset:26624
    v_mul_f32 v52, v38, v52
    v_mfma_f32_16x16x32_bf16 v[228:231], v[108:111], v[72:75], v[228:231]
    buffer_load_dwordx4 v62, s[36:39], s65 offen offset:2048 lds
    v_mfma_f32_16x16x32_bf16 v[232:235], v[112:115], v[68:71], v[232:235]
    s_nop 0
    ds_read_b128 a[108:111], v255 offset:27648
    ds_read_b128 a[112:115], v255 offset:28672
    v_mfma_f32_16x16x32_bf16 v[232:235], v[116:119], v[72:75], v[232:235]
    s_nop 0
    ds_read_b128 a[116:119], v255 offset:29696
    v_mul_f32 v53, v38, v53
    v_mfma_f32_16x16x32_bf16 v[236:239], v[120:123], v[68:71], v[236:239]
    s_nop 0
    ds_read_b128 a[120:123], v255 offset:30720
    v_mul_f32 v54, v38, v54
    v_mfma_f32_16x16x32_bf16 v[236:239], v[124:127], v[72:75], v[236:239]
    s_waitcnt lgkmcnt(6)
    ds_read_b128 a[124:127], v255 offset:31744
    v_mul_f32 v247, v38, v247
    v_mfma_f32_16x16x32_bf16 v[56:59], a[160:163], a[96:99], 0
    s_waitcnt lgkmcnt(5)
    ds_read_b128 a[128:131], v255 offset:32768
    v_mul_f32 v55, v38, v55
    v_mfma_f32_16x16x32_bf16 v[56:59], a[164:167], a[100:103], v[56:59]
    buffer_load_dwordx4 v63, s[36:39], s65 offen offset:3072 lds
    v_mfma_f32_16x16x32_bf16 v[56:59], a[168:171], a[104:107], v[56:59]
    s_waitcnt lgkmcnt(3)
    v_cvt_pk_bf16_f32 v64, v244, v245
    v_cvt_pk_bf16_f32 v66, v52, v53
    v_mfma_f32_16x16x32_bf16 v[56:59], a[172:175], a[108:111], v[56:59]
    s_add_u32 m0, s64, 32768
    ds_read_b128 a[132:135], v255 offset:33792
    v_cvt_pk_bf16_f32 v65, v246, v247
    v_mfma_f32_16x16x32_bf16 v[56:59], a[176:179], a[112:115], v[56:59]
    s_cmp_eq_u32 s71, 2
    s_cselect_b32 s42, 0, s69
    v_cvt_pk_bf16_f32 v67, v54, v55
    v_cvt_pk_bf16_f32 v208, v208, v209
    v_mfma_f32_16x16x32_bf16 v[56:59], a[180:183], a[116:119], v[56:59]
    s_lshl_b32 s65, s76, 7
    v_cvt_pk_bf16_f32 v216, v216, v217
    v_cvt_pk_bf16_f32 v209, v210, v211
    s_waitcnt lgkmcnt(3)
    v_mfma_f32_16x16x32_bf16 v[56:59], a[184:187], a[120:123], v[56:59]
    s_xor_b32 s63, s57, 4194304
    ds_read_b128 a[136:139], v255 offset:34816
    v_cvt_pk_bf16_f32 v217, v218, v219
    s_waitcnt lgkmcnt(3)
    v_mfma_f32_16x16x32_bf16 v[56:59], a[188:191], a[124:127], v[56:59]
    buffer_load_dwordx4 v60, s[36:39], s65 offen offset:0 lds
    v_mfma_f32_16x16x32_bf16 v[92:95], a[192:195], a[96:99], 0
    v_cvt_pk_bf16_f32 v210, v212, v213
    v_cvt_pk_bf16_f32 v218, v220, v221
    v_mfma_f32_16x16x32_bf16 v[92:95], a[196:199], a[100:103], v[92:95]
    v_cvt_pk_bf16_f32 v211, v214, v215
    v_cvt_pk_bf16_f32 v219, v222, v223
    v_mfma_f32_16x16x32_bf16 v[92:95], a[200:203], a[104:107], v[92:95]
    s_nop 0
    ds_read_b128 a[140:143], v255 offset:35840
    ds_read_b128 a[144:147], v255 offset:36864
    v_mfma_f32_16x16x32_bf16 v[92:95], a[204:207], a[108:111], v[92:95]
    s_nop 0
    ds_read_b128 a[148:151], v255 offset:37888
    v_mul_f32 v56, v39, v56
    v_mfma_f32_16x16x32_bf16 v[92:95], a[208:211], a[112:115], v[92:95]
    buffer_store_dwordx4 v[64:67], v248, s[40:43], s63 offen sc1
    v_mfma_f32_16x16x32_bf16 v[92:95], a[212:215], a[116:119], v[92:95]
    s_cmp_eq_u32 s42, 0
    s_cbranch_scc1 L_own2
    L_ownb2:
    ds_write_b128 v254, v[208:211] offset:40960
    v_mfma_f32_16x16x32_bf16 v[92:95], a[216:219], a[120:123], v[92:95]
    buffer_load_dwordx4 v61, s[36:39], s65 offen offset:1024 lds
    v_mfma_f32_16x16x32_bf16 v[92:95], a[220:223], a[124:127], v[92:95]
    s_waitcnt lgkmcnt(4)
    ds_write_b128 v254, v[216:219] offset:41984
    v_mfma_f32_16x16x32_bf16 v[240:243], a[160:163], a[128:131], 0
    s_nop 0
    ds_read_b128 a[152:155], v255 offset:38912
    ds_read_b128 a[156:159], v255 offset:39936
    v_mfma_f32_16x16x32_bf16 v[240:243], a[164:167], a[132:135], v[240:243]
    v_mul_f32 v57, v39, v57
    v_mul_f32 v58, v39, v58
    v_mfma_f32_16x16x32_bf16 v[240:243], a[168:171], a[136:139], v[240:243]
    s_waitcnt lgkmcnt(4)
    v_mul_f32 v92, v39, v92
    v_mul_f32 v93, v39, v93
    v_mfma_f32_16x16x32_bf16 v[240:243], a[172:175], a[140:143], v[240:243]
    buffer_load_dwordx4 v62, s[36:39], s65 offen offset:2048 lds
    v_mfma_f32_16x16x32_bf16 v[240:243], a[176:179], a[144:147], v[240:243]
    s_cmp_eq_u32 s71, 3
    s_cselect_b32 s42, 0, s69
    v_mul_f32 v94, v39, v94
    v_mul_f32 v59, v39, v59
    v_mfma_f32_16x16x32_bf16 v[240:243], a[180:183], a[148:151], v[240:243]
    s_waitcnt lgkmcnt(0)
    v_mul_f32 v95, v39, v95
    v_cvt_pk_bf16_f32 v32, v56, v57
    v_mfma_f32_16x16x32_bf16 v[240:243], a[184:187], a[152:155], v[240:243]
    s_xor_b32 s63, s57, 6299648
    v_cvt_pk_bf16_f32 v34, v92, v93
    v_cvt_pk_bf16_f32 v33, v58, v59
    v_mfma_f32_16x16x32_bf16 v[240:243], a[188:191], a[156:159], v[240:243]
    v_cvt_pk_bf16_f32 v35, v94, v95
    v_cvt_pk_bf16_f32 v224, v224, v225
    v_mfma_f32_16x16x32_bf16 v[244:247], a[192:195], a[128:131], 0
    s_waitcnt vmcnt(14)
    v_cvt_pk_bf16_f32 v232, v232, v233
    v_cvt_pk_bf16_f32 v225, v226, v227
    v_mfma_f32_16x16x32_bf16 v[244:247], a[196:199], a[132:135], v[244:247]
    s_barrier
    ds_read_b128 a[224:227], v255 offset:40960
    ds_read_b128 a[228:231], v255 offset:41984
    v_mfma_f32_16x16x32_bf16 v[244:247], a[200:203], a[136:139], v[244:247]
    s_nop 0
    ds_read_b128 a[232:235], v255 offset:43008
    v_cvt_pk_bf16_f32 v233, v234, v235
    v_mfma_f32_16x16x32_bf16 v[244:247], a[204:207], a[140:143], v[244:247]
    v_cvt_pk_bf16_f32 v226, v228, v229
    v_cvt_pk_bf16_f32 v234, v236, v237
    v_mfma_f32_16x16x32_bf16 v[244:247], a[208:211], a[144:147], v[244:247]
    buffer_store_dwordx4 v[32:35], v248, s[40:43], s63 offen sc1
    v_mfma_f32_16x16x32_bf16 v[244:247], a[212:215], a[148:151], v[244:247]
    s_cmp_eq_u32 s42, 0
    s_cbranch_scc1 L_own3
    L_ownb3:
    ds_read_b128 a[236:239], v255 offset:44032
    v_cvt_pk_bf16_f32 v227, v230, v231
    v_cvt_pk_bf16_f32 v235, v238, v239
    v_mfma_f32_16x16x32_bf16 v[244:247], a[216:219], a[152:155], v[244:247]
    buffer_load_dwordx4 v63, s[36:39], s65 offen offset:3072 lds
    ds_read_b128 a[240:243], v255 offset:45056
    v_mfma_f32_16x16x32_bf16 v[244:247], a[220:223], a[156:159], v[244:247]
    s_add_u32 m0, s64, 36864
    s_add_u32 s65, s65, 28672
    ds_write_b128 v254, v[224:227] offset:49152
    ds_read_b128 a[244:247], v255 offset:46080
    s_waitcnt lgkmcnt(6)
    v_mfma_f32_16x16x32_bf16 v[52:55], a[160:163], a[224:227], 0
    buffer_load_dwordx4 v60, s[36:39], s65 offen offset:0 lds
    ds_write_b128 v254, v[232:235] offset:50176
    ds_read_b128 a[248:251], v255 offset:47104
    s_waitcnt lgkmcnt(7)
    v_mfma_f32_16x16x32_bf16 v[52:55], a[164:167], a[228:231], v[52:55]
    s_cmp_eq_u32 s71, 0
    s_cselect_b32 s42, 0, s69
    ds_read_b128 a[252:255], v255 offset:48128
    v_mul_f32 v240, v40, v240
    s_waitcnt lgkmcnt(7)
    v_mfma_f32_16x16x32_bf16 v[52:55], a[168:171], a[232:235], v[52:55]
    s_xor_b32 s63, s57, 8388608
    v_mul_f32 v244, v40, v244
    v_mul_f32 v241, v40, v241
    s_waitcnt lgkmcnt(6)
    v_mfma_f32_16x16x32_bf16 v[52:55], a[172:175], a[236:239], v[52:55]
    s_waitcnt lgkmcnt(5)
    v_mul_f32 v245, v40, v245
    v_mul_f32 v242, v40, v242
    v_mfma_f32_16x16x32_bf16 v[52:55], a[176:179], a[240:243], v[52:55]
    s_waitcnt lgkmcnt(3)
    v_mul_f32 v246, v40, v246
    v_mul_f32 v243, v40, v243
    v_mfma_f32_16x16x32_bf16 v[52:55], a[180:183], a[244:247], v[52:55]
    s_waitcnt lgkmcnt(1)
    v_mul_f32 v247, v40, v247
    v_cvt_pk_bf16_f32 v64, v240, v241
    v_mfma_f32_16x16x32_bf16 v[52:55], a[184:187], a[248:251], v[52:55]
    s_waitcnt lgkmcnt(0)
    v_cvt_pk_bf16_f32 v66, v244, v245
    v_cvt_pk_bf16_f32 v65, v242, v243
    v_mfma_f32_16x16x32_bf16 v[52:55], a[188:191], a[252:255], v[52:55]
    v_cvt_pk_bf16_f32 v67, v246, v247
    v_add_f32 v46, v44, v45
    v_mfma_f32_16x16x32_bf16 v[56:59], a[192:195], a[224:227], 0
    buffer_store_dwordx4 v[64:67], v248, s[40:43], s63 offen sc1
    v_mfma_f32_16x16x32_bf16 v[56:59], a[196:199], a[228:231], v[56:59]
    s_cmp_eq_u32 s42, 0
    s_cbranch_scc1 L_own4
    L_ownb4:
    ds_read_b64_tr_b16 v[128:129], v251 offset:0
    ds_read_b64_tr_b16 v[130:131], v251 offset:2048
    v_mfma_f32_16x16x32_bf16 v[56:59], a[200:203], a[232:235], v[56:59]
    s_barrier
    buffer_load_dwordx4 v61, s[36:39], s65 offen offset:1024 lds
    ds_read_b128 v[96:99], v255 offset:49152
    v_mfma_f32_16x16x32_bf16 v[56:59], a[204:207], a[236:239], v[56:59]
    s_nop 0
    ds_read_b128 v[100:103], v255 offset:50176
    ds_read_b128 v[104:107], v255 offset:51200
    v_mfma_f32_16x16x32_bf16 v[56:59], a[208:211], a[240:243], v[56:59]
    buffer_load_dwordx4 v62, s[36:39], s65 offen offset:2048 lds
    v_mfma_f32_16x16x32_bf16 v[56:59], a[212:215], a[244:247], v[56:59]
    s_nop 0
    ds_read_b128 v[108:111], v255 offset:52224
    ds_read_b128 v[112:115], v255 offset:53248
    v_mfma_f32_16x16x32_bf16 v[56:59], a[216:219], a[248:251], v[56:59]
    s_nop 0
    ds_read_b64_tr_b16 v[132:133], v251 offset:4096
    ds_read_b128 v[116:119], v255 offset:54272
    v_mfma_f32_16x16x32_bf16 v[56:59], a[220:223], a[252:255], v[56:59]
    s_waitcnt lgkmcnt(4)
    ds_read_b64_tr_b16 v[134:135], v251 offset:6144
    ds_read_b64_tr_b16 v[136:137], v251 offset:8192
    v_mfma_f32_16x16x32_bf16 v[92:95], a[160:163], v[96:99], 0
    s_cmp_eq_u32 s71, 1
    s_cselect_b32 s42, 0, s69
    ds_read_b128 v[120:123], v255 offset:55296
    ds_read_b64_tr_b16 v[138:139], v251 offset:10240
    v_mfma_f32_16x16x32_bf16 v[92:95], a[164:167], v[100:103], v[92:95]
    buffer_load_dwordx4 v63, s[36:39], s65 offen offset:3072 lds
    ds_read_b128 v[124:127], v255 offset:56320
    v_mfma_f32_16x16x32_bf16 v[92:95], a[168:171], v[104:107], v[92:95]
    s_xor_b32 s63, s57, 10493952
    ds_read_b64_tr_b16 v[140:141], v251 offset:12288
    ds_read_b64_tr_b16 v[142:143], v251 offset:14336
    ds_read_b64_tr_b16 v[144:145], v251 offset:16384
    ds_read_b64_tr_b16 v[146:147], v251 offset:18432
    s_waitcnt lgkmcnt(12)
    v_mfma_f32_16x16x32_bf16 v[92:95], a[172:175], v[108:111], v[92:95]
    s_waitcnt lgkmcnt(11)
    ds_read_b64_tr_b16 v[148:149], v251 offset:20480
    ds_read_b64_tr_b16 v[150:151], v251 offset:22528
    v_mfma_f32_16x16x32_bf16 v[92:95], a[176:179], v[112:115], v[92:95]
    s_waitcnt lgkmcnt(11)
    ds_read_b64_tr_b16 v[152:153], v251 offset:24576
    ds_read_b64_tr_b16 v[154:155], v251 offset:26624
    v_mfma_f32_16x16x32_bf16 v[92:95], a[180:183], v[116:119], v[92:95]
    s_waitcnt lgkmcnt(8)
    ds_read_b64_tr_b16 v[156:157], v251 offset:28672
    ds_read_b64_tr_b16 v[158:159], v251 offset:30720
    v_mul_f32 v52, v41, v52
    v_mul_f32 v56, v41, v56
    v_mul_f32 v53, v41, v53
    v_mul_f32 v57, v41, v57
    v_mfma_f32_16x16x32_bf16 v[92:95], a[184:187], v[120:123], v[92:95]
    s_add_u32 m0, s64, 65536
    v_mul_f32 v54, v41, v54
    v_mul_f32 v58, v41, v58
    v_mul_f32 v55, v41, v55
    v_mul_f32 v59, v41, v59
    v_mfma_f32_16x16x32_bf16 v[92:95], a[188:191], v[124:127], v[92:95]
    s_lshl_b32 s65, s77, 7
    v_cvt_pk_bf16_f32 v32, v52, v53
    v_cvt_pk_bf16_f32 v34, v56, v57
    v_cvt_pk_bf16_f32 v33, v54, v55
    v_cvt_pk_bf16_f32 v35, v58, v59
    v_mfma_f32_16x16x32_bf16 v[240:243], a[192:195], v[96:99], 0
    s_waitcnt vmcnt(11) lgkmcnt(0)
    buffer_store_dwordx4 v[32:35], v248, s[40:43], s63 offen sc1
    v_mfma_f32_16x16x32_bf16 v[240:243], a[196:199], v[100:103], v[240:243]
    s_barrier
    s_cmp_eq_u32 s42, 0
    s_cbranch_scc1 L_own5
    L_ownb5:
    ds_read_b64_tr_b16 v[160:161], v250 offset:0
    v_mfma_f32_16x16x32_bf16 v[240:243], a[200:203], v[104:107], v[240:243]
    buffer_load_dwordx4 v60, s[36:39], s65 offen offset:0 lds
    v_mfma_f32_16x16x32_bf16 v[240:243], a[204:207], v[108:111], v[240:243]
    s_nop 0
    ds_read_b64_tr_b16 v[162:163], v250 offset:2048
    ds_read_b64_tr_b16 v[164:165], v250 offset:4096
    v_mfma_f32_16x16x32_bf16 v[240:243], a[208:211], v[112:115], v[240:243]
    s_nop 0
    ds_read_b64_tr_b16 v[166:167], v250 offset:6144
    ds_read_b64_tr_b16 v[168:169], v250 offset:8192
    v_mfma_f32_16x16x32_bf16 v[240:243], a[212:215], v[116:119], v[240:243]
    buffer_load_dwordx4 v61, s[36:39], s65 offen offset:1024 lds
    v_mfma_f32_16x16x32_bf16 v[240:243], a[216:219], v[120:123], v[240:243]
    s_nop 0
    ds_read_b64_tr_b16 v[170:171], v250 offset:10240
    ds_read_b64_tr_b16 v[172:173], v250 offset:12288
    v_mfma_f32_16x16x32_bf16 v[240:243], a[220:223], v[124:127], v[240:243]
    s_nop 0
    ds_read_b64_tr_b16 v[174:175], v250 offset:14336
    v_mul_f32 v92, v42, v92
    v_mfma_f32_16x16x32_bf16 v[244:247], v[128:131], a[0:3], 0
    s_cmp_eq_u32 s71, 2
    s_cselect_b32 s42, 0, s69
    ds_read_b64_tr_b16 v[176:177], v250 offset:16384
    v_mul_f32 v93, v42, v93
    v_mfma_f32_16x16x32_bf16 v[244:247], v[132:135], a[4:7], v[244:247]
    s_nop 0
    ds_read_b64_tr_b16 v[178:179], v250 offset:18432
    v_mul_f32 v94, v42, v94
    v_mfma_f32_16x16x32_bf16 v[244:247], v[136:139], a[8:11], v[244:247]
    s_xor_b32 s63, s57, 12582912
    v_mul_f32 v240, v42, v240
    v_mul_f32 v241, v42, v241
    v_mfma_f32_16x16x32_bf16 v[244:247], v[140:143], a[12:15], v[244:247]
    buffer_load_dwordx4 v62, s[36:39], s65 offen offset:2048 lds
    v_mfma_f32_16x16x32_bf16 v[244:247], v[144:147], a[16:19], v[244:247]
    v_mul_f32 v242, v42, v242
    v_mul_f32 v95, v42, v95
    v_mfma_f32_16x16x32_bf16 v[244:247], v[148:151], a[20:23], v[244:247]
    s_nop 0
    ds_read_b64_tr_b16 v[180:181], v250 offset:20480
    v_mul_f32 v243, v42, v243
    v_mfma_f32_16x16x32_bf16 v[244:247], v[152:155], a[24:27], v[244:247]
    v_cvt_pk_bf16_f32 v64, v92, v93
    v_cvt_pk_bf16_f32 v66, v240, v241
    v_mfma_f32_16x16x32_bf16 v[244:247], v[156:159], a[28:31], v[244:247]
    s_waitcnt lgkmcnt(3)
    ds_read_b64_tr_b16 v[182:183], v250 offset:22528
    v_cvt_pk_bf16_f32 v65, v94, v95
    v_cvt_pk_bf16_f32 v67, v242, v243
    v_mfma_f32_16x16x32_bf16 v[52:55], v[160:163], a[0:3], 0
    buffer_store_dwordx4 v[64:67], v248, s[40:43], s63 offen sc1
    ds_read_b64_tr_b16 v[184:185], v250 offset:24576
    ds_read_b64_tr_b16 v[186:187], v250 offset:26624
    v_mfma_f32_16x16x32_bf16 v[52:55], v[164:167], a[4:7], v[52:55]
    s_cmp_eq_u32 s42, 0
    s_cbranch_scc1 L_own6
    L_ownb6:
    ds_read_b64_tr_b16 v[188:189], v250 offset:28672
    ds_read_b64_tr_b16 v[190:191], v250 offset:30720
    v_mfma_f32_16x16x32_bf16 v[52:55], v[168:171], a[8:11], v[52:55]
    buffer_load_dwordx4 v63, s[36:39], s65 offen offset:3072 lds
    v_mfma_f32_16x16x32_bf16 v[52:55], v[172:175], a[12:15], v[52:55]
    s_waitcnt lgkmcnt(2)
    v_mul_f32 v244, v36, v244
    v_mul_f32 v245, v36, v245
    v_mfma_f32_16x16x32_bf16 v[52:55], v[176:179], a[16:19], v[52:55]
    s_add_u32 m0, s64, 69632
    v_mul_f32 v246, v36, v246
    v_mul_f32 v247, v36, v247
    v_mfma_f32_16x16x32_bf16 v[52:55], v[180:183], a[20:23], v[52:55]
    s_add_u32 s65, s65, 28672
    v_cvt_pk_bf16_f32 v32, v244, v245
    v_cvt_pk_bf16_f32 v33, v246, v247
    v_mfma_f32_16x16x32_bf16 v[52:55], v[184:187], a[24:27], v[52:55]
    s_cmp_eq_u32 s71, 3
    s_cselect_b32 s42, 0, s69
    v_mov_b32 v47, 0x53800000
    v_cmp_nle_f32 vcc, v46, v47
    s_waitcnt lgkmcnt(0)
    v_mfma_f32_16x16x32_bf16 v[52:55], v[188:191], a[28:31], v[52:55]
    buffer_load_dwordx4 v60, s[36:39], s65 offen offset:0 lds
    v_mfma_f32_16x16x32_bf16 v[56:59], v[128:131], a[32:35], 0
    s_xor_b32 s63, s57, 14688256
    v_mfma_f32_16x16x32_bf16 v[56:59], v[132:135], a[36:39], v[56:59]
    s_cbranch_vccnz L_fallback
    L_nofb:
    v_mfma_f32_16x16x32_bf16 v[56:59], v[136:139], a[40:43], v[56:59]
    s_and_b32 s12, s58, 3
    v_mul_f32 v52, v36, v52
    v_mul_f32 v53, v36, v53
    v_mfma_f32_16x16x32_bf16 v[56:59], v[140:143], a[44:47], v[56:59]
    s_lshr_b32 s13, s58, 2
    v_mul_f32 v54, v36, v54
    v_mul_f32 v55, v36, v55
    v_mfma_f32_16x16x32_bf16 v[56:59], v[144:147], a[48:51], v[56:59]
    s_add_u32 s4, s12, 0
    v_cvt_pk_bf16_f32 v34, v52, v53
    v_cvt_pk_bf16_f32 v35, v54, v55
    v_mfma_f32_16x16x32_bf16 v[56:59], v[148:151], a[52:55], v[56:59]
    s_and_b32 s4, s4, 3
    s_lshl_b32 s4, s4, 2
    s_lshr_b32 s4, 0x5410, s4
    v_mfma_f32_16x16x32_bf16 v[56:59], v[152:155], a[56:59], v[56:59]
    buffer_store_dwordx4 v[32:35], v248, s[40:43], s63 offen sc1
    v_mfma_f32_16x16x32_bf16 v[56:59], v[156:159], a[60:63], v[56:59]
    s_cmp_eq_u32 s42, 0
    s_cbranch_scc1 L_own7
    L_ownb7:
    s_and_b32 s4, s4, 15
    s_lshl_b32 s4, s4, 12
    v_mfma_f32_16x16x32_bf16 v[92:95], v[160:163], a[32:35], 0
    buffer_load_dwordx4 v61, s[36:39], s65 offen offset:1024 lds
    v_mfma_f32_16x16x32_bf16 v[92:95], v[164:167], a[36:39], v[92:95]
    s_add_u32 s5, s12, 1
    s_and_b32 s5, s5, 3
    s_lshl_b32 s5, s5, 2
    v_mfma_f32_16x16x32_bf16 v[92:95], v[168:171], a[40:43], v[92:95]
    s_lshr_b32 s5, 0x5410, s5
    v_mul_f32 v56, v37, v56
    v_mul_f32 v57, v37, v57
    v_mfma_f32_16x16x32_bf16 v[92:95], v[172:175], a[44:47], v[92:95]
    buffer_load_dwordx4 v62, s[36:39], s65 offen offset:2048 lds
    v_mfma_f32_16x16x32_bf16 v[92:95], v[176:179], a[48:51], v[92:95]
    s_and_b32 s5, s5, 15
    v_mul_f32 v58, v37, v58
    v_mul_f32 v59, v37, v59
    v_mfma_f32_16x16x32_bf16 v[92:95], v[180:183], a[52:55], v[92:95]
    s_lshl_b32 s5, s5, 12
    v_cvt_pk_bf16_f32 v64, v56, v57
    v_cvt_pk_bf16_f32 v65, v58, v59
    v_mfma_f32_16x16x32_bf16 v[92:95], v[184:187], a[56:59], v[92:95]
    s_cmp_eq_u32 s71, 0
    s_cselect_b32 s42, 0, s69
    s_add_u32 s6, s12, 2
    s_and_b32 s6, s6, 3
    v_mfma_f32_16x16x32_bf16 v[92:95], v[188:191], a[60:63], v[92:95]
    s_lshl_b32 s6, s6, 2
    s_lshr_b32 s6, 0x5410, s6
    s_and_b32 s6, s6, 15
    v_mfma_f32_16x16x32_bf16 v[240:243], v[128:131], a[64:67], 0
    s_xor_b32 s63, s57, 16777216
    s_lshl_b32 s6, s6, 12
    s_add_u32 s7, s12, 3
    v_mfma_f32_16x16x32_bf16 v[240:243], v[132:135], a[68:71], v[240:243]
    buffer_load_dwordx4 v63, s[36:39], s65 offen offset:3072 lds
    v_mfma_f32_16x16x32_bf16 v[240:243], v[136:139], a[72:75], v[240:243]
    s_and_b32 s7, s7, 3
    v_mul_f32 v92, v37, v92
    v_mul_f32 v93, v37, v93
    v_mfma_f32_16x16x32_bf16 v[240:243], v[140:143], a[76:79], v[240:243]
    s_lshl_b32 s7, s7, 2
    v_mul_f32 v94, v37, v94
    v_mul_f32 v95, v37, v95
    v_mfma_f32_16x16x32_bf16 v[240:243], v[144:147], a[80:83], v[240:243]
    s_lshr_b32 s7, 0x5410, s7
    v_cvt_pk_bf16_f32 v66, v92, v93
    v_cvt_pk_bf16_f32 v67, v94, v95
    v_mfma_f32_16x16x32_bf16 v[240:243], v[148:151], a[84:87], v[240:243]
    s_and_b32 s7, s7, 15
    s_lshl_b32 s7, s7, 12
    s_lshl_b32 s8, s13, 11
    v_mfma_f32_16x16x32_bf16 v[240:243], v[152:155], a[88:91], v[240:243]
    s_waitcnt vmcnt(11)
    buffer_store_dwordx4 v[64:67], v248, s[40:43], s63 offen sc1
    v_mfma_f32_16x16x32_bf16 v[240:243], v[156:159], a[92:95], v[240:243]
    s_barrier
    s_cmp_eq_u32 s42, 0
    s_cbranch_scc1 L_own8
    L_ownb8:
    s_add_u32 m0, s64, 0
    s_lshl_b32 s65, s78, 7
    ds_read_b64_tr_b16 a[160:161], v250 offset:32768
    v_mfma_f32_16x16x32_bf16 v[244:247], v[160:163], a[64:67], 0
    buffer_load_dwordx4 v60, s[36:39], s65 offen offset:0 lds
    v_mfma_f32_16x16x32_bf16 v[244:247], v[164:167], a[68:71], v[244:247]
    s_add_u32 s8, s8, s12
    ds_read_b64_tr_b16 a[162:163], v250 offset:34816
    ds_read_b64_tr_b16 a[164:165], v250 offset:36864
    v_mfma_f32_16x16x32_bf16 v[244:247], v[168:171], a[72:75], v[244:247]
    s_lshl_b32 s8, s8, 10
    v_mul_f32 v240, v38, v240
    v_mul_f32 v241, v38, v241
    v_mfma_f32_16x16x32_bf16 v[244:247], v[172:175], a[76:79], v[244:247]
    s_and_b32 s9, s13, 1
    v_mul_f32 v242, v38, v242
    v_mul_f32 v243, v38, v243
    v_mfma_f32_16x16x32_bf16 v[244:247], v[176:179], a[80:83], v[244:247]
    s_lshl_b32 s9, s9, 13
    v_cvt_pk_bf16_f32 v32, v240, v241
    v_cvt_pk_bf16_f32 v33, v242, v243
    v_mfma_f32_16x16x32_bf16 v[244:247], v[180:183], a[84:87], v[244:247]
    s_xor_b32 s9, s9, s57
    ds_read_b64_tr_b16 a[166:167], v250 offset:38912
    ds_read_b64_tr_b16 a[168:169], v250 offset:40960
    v_mfma_f32_16x16x32_bf16 v[244:247], v[184:187], a[88:91], v[244:247]
    s_cmp_eq_u32 s71, 1
    s_cselect_b32 s42, 0, s69
    ds_read_b64_tr_b16 a[170:171], v250 offset:43008
    ds_read_b64_tr_b16 a[172:173], v250 offset:45056
    v_mfma_f32_16x16x32_bf16 v[244:247], v[188:191], a[92:95], v[244:247]
    buffer_load_dwordx4 v61, s[36:39], s65 offen offset:1024 lds
    v_mfma_f32_16x16x32_bf16 v[52:55], v[128:131], a[96:99], 0
    s_xor_b32 s63, s57, 18882560
    ds_read_b64_tr_b16 a[174:175], v250 offset:47104
    ds_read_b64_tr_b16 a[176:177], v250 offset:49152
    v_mfma_f32_16x16x32_bf16 v[52:55], v[132:135], a[100:103], v[52:55]
    s_add_u32 s8, s8, s9
    ds_read_b64_tr_b16 a[178:179], v250 offset:51200
    ds_read_b64_tr_b16 a[180:181], v250 offset:53248
    v_mfma_f32_16x16x32_bf16 v[52:55], v[136:139], a[104:107], v[52:55]
    v_mul_f32 v244, v38, v244
    v_mul_f32 v245, v38, v245
    v_mfma_f32_16x16x32_bf16 v[52:55], v[140:143], a[108:111], v[52:55]
    v_mul_f32 v246, v38, v246
    v_mul_f32 v247, v38, v247
    v_mfma_f32_16x16x32_bf16 v[52:55], v[144:147], a[112:115], v[52:55]
    v_cvt_pk_bf16_f32 v34, v244, v245
    v_cvt_pk_bf16_f32 v35, v246, v247
    v_mfma_f32_16x16x32_bf16 v[52:55], v[148:151], a[116:119], v[52:55]
    s_nop 0
    ds_read_b64_tr_b16 a[182:183], v250 offset:55296
    ds_read_b64_tr_b16 a[184:185], v250 offset:57344
    v_mfma_f32_16x16x32_bf16 v[52:55], v[152:155], a[120:123], v[52:55]
    buffer_store_dwordx4 v[32:35], v248, s[40:43], s63 offen sc1
    v_mfma_f32_16x16x32_bf16 v[52:55], v[156:159], a[124:127], v[52:55]
    s_cmp_eq_u32 s42, 0
    s_cbranch_scc1 L_own9
    L_ownb9:
    ds_read_b64_tr_b16 a[186:187], v250 offset:59392
    ds_read_b64_tr_b16 a[188:189], v250 offset:61440
    v_mfma_f32_16x16x32_bf16 v[56:59], v[160:163], a[96:99], 0
    buffer_load_dwordx4 v62, s[36:39], s65 offen offset:2048 lds
    v_mfma_f32_16x16x32_bf16 v[56:59], v[164:167], a[100:103], v[56:59]
    s_nop 0
    ds_read_b64_tr_b16 a[190:191], v250 offset:63488
    v_lshl_add_u32 v81, v2, 4, v3
    v_mfma_f32_16x16x32_bf16 v[56:59], v[168:171], a[104:107], v[56:59]
    v_mul_f32 v52, v39, v52
    v_mul_f32 v53, v39, v53
    v_mfma_f32_16x16x32_bf16 v[56:59], v[172:175], a[108:111], v[56:59]
    v_mul_f32 v54, v39, v54
    v_mul_f32 v55, v39, v55
    v_mfma_f32_16x16x32_bf16 v[56:59], v[176:179], a[112:115], v[56:59]
    v_cvt_pk_bf16_f32 v64, v52, v53
    v_cvt_pk_bf16_f32 v65, v54, v55
    v_mfma_f32_16x16x32_bf16 v[56:59], v[180:183], a[116:119], v[56:59]
    v_lshlrev_b32 v81, 4, v81
    v_lshl_add_u32 v80, v4, 15, v81
    v_mfma_f32_16x16x32_bf16 v[56:59], v[184:187], a[120:123], v[56:59]
    s_cmp_eq_u32 s71, 2
    s_cselect_b32 s42, 0, s69
    v_add_u32 v80, s8, v80
    v_add_u32 v81, 155648, v81
    v_mfma_f32_16x16x32_bf16 v[56:59], v[188:191], a[124:127], v[56:59]
    buffer_load_dwordx4 v63, s[36:39], s65 offen offset:3072 lds
    v_mfma_f32_16x16x32_bf16 v[92:95], v[128:131], a[128:131], 0
    s_xor_b32 s63, s57, 20971520
    s_lshl_b32 s14, s13, 4
    s_mov_b32 s10, 0xffff
    v_mfma_f32_16x16x32_bf16 v[92:95], v[132:135], a[132:135], v[92:95]
    s_mov_b32 s11, 0
    s_lshl_b64 s[10:11], s[10:11], s14
    v_mfma_f32_16x16x32_bf16 v[92:95], v[136:139], a[136:139], v[92:95]
    v_mul_f32 v56, v39, v56
    v_mul_f32 v57, v39, v57
    v_mfma_f32_16x16x32_bf16 v[92:95], v[140:143], a[140:143], v[92:95]
    v_mul_f32 v58, v39, v58
    v_mul_f32 v59, v39, v59
    v_mfma_f32_16x16x32_bf16 v[92:95], v[144:147], a[144:147], v[92:95]
    v_cvt_pk_bf16_f32 v66, v56, v57
    v_cvt_pk_bf16_f32 v67, v58, v59
    v_mfma_f32_16x16x32_bf16 v[92:95], v[148:151], a[148:151], v[92:95]
    v_mfma_f32_16x16x32_bf16 v[92:95], v[152:155], a[152:155], v[92:95]
    buffer_store_dwordx4 v[64:67], v248, s[40:43], s63 offen sc1
    v_mfma_f32_16x16x32_bf16 v[92:95], v[156:159], a[156:159], v[92:95]
    s_cmp_eq_u32 s42, 0
    s_cbranch_scc1 L_own10
    L_ownb10:
    s_add_u32 m0, s64, 4096
    s_add_u32 s65, s65, 28672
    v_mfma_f32_16x16x32_bf16 v[240:243], v[160:163], a[128:131], 0
    buffer_load_dwordx4 v60, s[36:39], s65 offen offset:0 lds
    v_mfma_f32_16x16x32_bf16 v[240:243], v[164:167], a[132:135], v[240:243]
    v_mfma_f32_16x16x32_bf16 v[240:243], v[168:171], a[136:139], v[240:243]
    v_mul_f32 v92, v40, v92
    v_mul_f32 v93, v40, v93
    v_mfma_f32_16x16x32_bf16 v[240:243], v[172:175], a[140:143], v[240:243]
    v_mul_f32 v94, v40, v94
    v_mul_f32 v95, v40, v95
    v_mfma_f32_16x16x32_bf16 v[240:243], v[176:179], a[144:147], v[240:243]
    v_cvt_pk_bf16_f32 v32, v92, v93
    v_cvt_pk_bf16_f32 v33, v94, v95
    v_mfma_f32_16x16x32_bf16 v[240:243], v[180:183], a[148:151], v[240:243]
    v_mfma_f32_16x16x32_bf16 v[240:243], v[184:187], a[152:155], v[240:243]
    s_cmp_eq_u32 s71, 3
    s_cselect_b32 s42, 0, s69
    v_mfma_f32_16x16x32_bf16 v[240:243], v[188:191], a[156:159], v[240:243]
    buffer_load_dwordx4 v61, s[36:39], s65 offen offset:1024 lds
    v_mfma_f32_16x16x32_bf16 v[244:247], v[128:131], a[224:227], 0
    s_xor_b32 s63, s57, 23076864
    v_mfma_f32_16x16x32_bf16 v[244:247], v[132:135], a[228:231], v[244:247]
    v_mfma_f32_16x16x32_bf16 v[244:247], v[136:139], a[232:235], v[244:247]
    v_mul_f32 v240, v40, v240
    v_mul_f32 v241, v40, v241
    v_mfma_f32_16x16x32_bf16 v[244:247], v[140:143], a[236:239], v[244:247]
    v_mul_f32 v242, v40, v242
    v_mul_f32 v243, v40, v243
    v_mfma_f32_16x16x32_bf16 v[244:247], v[144:147], a[240:243], v[244:247]
    v_cvt_pk_bf16_f32 v34, v240, v241
    v_cvt_pk_bf16_f32 v35, v242, v243
    v_mfma_f32_16x16x32_bf16 v[244:247], v[148:151], a[244:247], v[244:247]
    v_mfma_f32_16x16x32_bf16 v[244:247], v[152:155], a[248:251], v[244:247]
    buffer_store_dwordx4 v[32:35], v248, s[40:43], s63 offen sc1
    v_mfma_f32_16x16x32_bf16 v[244:247], v[156:159], a[252:255], v[244:247]
    s_cmp_eq_u32 s42, 0
    s_cbranch_scc1 L_own11
    L_ownb11:
    v_mfma_f32_16x16x32_bf16 v[52:55], v[160:163], a[224:227], 0
    buffer_load_dwordx4 v62, s[36:39], s65 offen offset:2048 lds
    v_mfma_f32_16x16x32_bf16 v[52:55], v[164:167], a[228:231], v[52:55]
    v_mfma_f32_16x16x32_bf16 v[52:55], v[168:171], a[232:235], v[52:55]
    v_mul_f32 v244, v41, v244
    v_mul_f32 v245, v41, v245
    v_mfma_f32_16x16x32_bf16 v[52:55], v[172:175], a[236:239], v[52:55]
    v_mul_f32 v246, v41, v246
    v_mul_f32 v247, v41, v247
    v_mfma_f32_16x16x32_bf16 v[52:55], v[176:179], a[240:243], v[52:55]
    s_waitcnt vmcnt(11)
    v_cvt_pk_bf16_f32 v64, v244, v245
    v_cvt_pk_bf16_f32 v65, v246, v247
    v_mfma_f32_16x16x32_bf16 v[52:55], v[180:183], a[244:247], v[52:55]
    s_barrier
    ds_read_b64_tr_b16 a[192:193], v251 offset:0
    ds_read_b64_tr_b16 a[194:195], v251 offset:2048
    v_mfma_f32_16x16x32_bf16 v[52:55], v[184:187], a[248:251], v[52:55]
    s_cmp_eq_u32 s71, 0
    s_cselect_b32 s42, 0, s69
    ds_read_b64_tr_b16 a[196:197], v251 offset:4096
    ds_read_b64_tr_b16 a[198:199], v251 offset:6144
    v_mfma_f32_16x16x32_bf16 v[52:55], v[188:191], a[252:255], v[52:55]
    buffer_load_dwordx4 v63, s[36:39], s65 offen offset:3072 lds
    v_mfma_f32_16x16x32_bf16 v[56:59], v[128:131], v[96:99], 0
    s_xor_b32 s63, s57, 25165824
    ds_read_b64_tr_b16 a[200:201], v251 offset:8192
    ds_read_b64_tr_b16 a[202:203], v251 offset:10240
    v_mfma_f32_16x16x32_bf16 v[56:59], v[132:135], v[100:103], v[56:59]
    s_nop 0
    ds_read_b64_tr_b16 a[204:205], v251 offset:12288
    ds_read_b64_tr_b16 a[206:207], v251 offset:14336
    v_mfma_f32_16x16x32_bf16 v[56:59], v[136:139], v[104:107], v[56:59]
    v_mul_f32 v52, v41, v52
    v_mul_f32 v53, v41, v53
    v_mfma_f32_16x16x32_bf16 v[56:59], v[140:143], v[108:111], v[56:59]
    v_mul_f32 v54, v41, v54
    v_mul_f32 v55, v41, v55
    v_mfma_f32_16x16x32_bf16 v[56:59], v[144:147], v[112:115], v[56:59]
    v_cvt_pk_bf16_f32 v66, v52, v53
    v_cvt_pk_bf16_f32 v67, v54, v55
    v_mfma_f32_16x16x32_bf16 v[56:59], v[148:151], v[116:119], v[56:59]
    s_nop 0
    ds_read_b64_tr_b16 a[208:209], v251 offset:16384
    ds_read_b64_tr_b16 a[210:211], v251 offset:18432
    v_mfma_f32_16x16x32_bf16 v[56:59], v[152:155], v[120:123], v[56:59]
    buffer_store_dwordx4 v[64:67], v248, s[40:43], s63 offen sc1
    v_mfma_f32_16x16x32_bf16 v[56:59], v[156:159], v[124:127], v[56:59]
    s_cmp_eq_u32 s42, 0
    s_cbranch_scc1 L_own12
    L_ownb12:
    ds_read_b64_tr_b16 a[212:213], v251 offset:20480
    ds_read_b64_tr_b16 a[214:215], v251 offset:22528
    v_mfma_f32_16x16x32_bf16 v[92:95], v[160:163], v[96:99], 0
    s_nop 0
    ds_read_b64_tr_b16 a[216:217], v251 offset:24576
    ds_read_b64_tr_b16 a[218:219], v251 offset:26624
    v_mfma_f32_16x16x32_bf16 v[92:95], v[164:167], v[100:103], v[92:95]
    s_nop 0
    ds_read_b64_tr_b16 a[220:221], v251 offset:28672
    ds_read_b64_tr_b16 a[222:223], v251 offset:30720
    v_mfma_f32_16x16x32_bf16 v[92:95], v[168:171], v[104:107], v[92:95]
    v_mul_f32 v56, v42, v56
    v_mul_f32 v57, v42, v57
    v_mfma_f32_16x16x32_bf16 v[92:95], v[172:175], v[108:111], v[92:95]
    v_mul_f32 v58, v42, v58
    v_mul_f32 v59, v42, v59
    v_mfma_f32_16x16x32_bf16 v[92:95], v[176:179], v[112:115], v[92:95]
    v_cvt_pk_bf16_f32 v32, v56, v57
    v_cvt_pk_bf16_f32 v33, v58, v59
    v_mfma_f32_16x16x32_bf16 v[92:95], v[180:183], v[116:119], v[92:95]
    v_mfma_f32_16x16x32_bf16 v[92:95], v[184:187], v[120:123], v[92:95]
    s_cmp_eq_u32 s71, 1
    s_cselect_b32 s42, 0, s69
    v_mfma_f32_16x16x32_bf16 v[92:95], v[188:191], v[124:127], v[92:95]
    s_waitcnt lgkmcnt(4)
    v_mfma_f32_16x16x32_bf16 v[240:243], a[160:163], a[0:3], 0
    s_xor_b32 s63, s57, 27271168
    v_mfma_f32_16x16x32_bf16 v[240:243], a[164:167], a[4:7], v[240:243]
    v_mfma_f32_16x16x32_bf16 v[240:243], a[168:171], a[8:11], v[240:243]
    v_mul_f32 v92, v42, v92
    v_mul_f32 v93, v42, v93
    v_mfma_f32_16x16x32_bf16 v[240:243], a[172:175], a[12:15], v[240:243]
    v_mul_f32 v94, v42, v94
    v_mul_f32 v95, v42, v95
    v_mfma_f32_16x16x32_bf16 v[240:243], a[176:179], a[16:19], v[240:243]
    v_cvt_pk_bf16_f32 v34, v92, v93
    v_cvt_pk_bf16_f32 v35, v94, v95
    v_mfma_f32_16x16x32_bf16 v[240:243], a[180:183], a[20:23], v[240:243]
    v_mfma_f32_16x16x32_bf16 v[240:243], a[184:187], a[24:27], v[240:243]
    buffer_store_dwordx4 v[32:35], v248, s[40:43], s63 offen sc1
    v_mfma_f32_16x16x32_bf16 v[240:243], a[188:191], a[28:31], v[240:243]
    s_cmp_eq_u32 s42, 0
    s_cbranch_scc1 L_own13
    L_ownb13:
    v_mfma_f32_16x16x32_bf16 v[244:247], a[192:195], a[0:3], 0
    v_mfma_f32_16x16x32_bf16 v[244:247], a[196:199], a[4:7], v[244:247]
    v_mfma_f32_16x16x32_bf16 v[244:247], a[200:203], a[8:11], v[244:247]
    v_mul_f32 v240, v36, v240
    v_mul_f32 v241, v36, v241
    v_mfma_f32_16x16x32_bf16 v[244:247], a[204:207], a[12:15], v[244:247]
    v_mul_f32 v242, v36, v242
    v_mul_f32 v243, v36, v243
    v_mfma_f32_16x16x32_bf16 v[244:247], a[208:211], a[16:19], v[244:247]
    v_cvt_pk_bf16_f32 v64, v240, v241
    v_cvt_pk_bf16_f32 v65, v242, v243
    v_mfma_f32_16x16x32_bf16 v[244:247], a[212:215], a[20:23], v[244:247]
    s_waitcnt lgkmcnt(0)
    v_mfma_f32_16x16x32_bf16 v[244:247], a[216:219], a[24:27], v[244:247]
    s_cmp_eq_u32 s71, 2
    s_cselect_b32 s42, 0, s69
    v_mfma_f32_16x16x32_bf16 v[244:247], a[220:223], a[28:31], v[244:247]
    v_mfma_f32_16x16x32_bf16 v[52:55], a[160:163], a[32:35], 0
    s_xor_b32 s63, s57, 29360128
    v_mfma_f32_16x16x32_bf16 v[52:55], a[164:167], a[36:39], v[52:55]
    v_mfma_f32_16x16x32_bf16 v[52:55], a[168:171], a[40:43], v[52:55]
    s_barrier
    s_cmp_lg_u32 s56, 0
    s_cbranch_scc1 L_nf1
    s_mov_b32 s61, 0x1
    s_atomic_add s61, s[52:53], s57
    L_nf1:
    v_mul_f32 v244, v36, v244
    v_mul_f32 v245, v36, v245
    v_mfma_f32_16x16x32_bf16 v[52:55], a[172:175], a[44:47], v[52:55]
    v_mul_f32 v246, v36, v246
    v_mul_f32 v247, v36, v247
    v_mfma_f32_16x16x32_bf16 v[52:55], a[176:179], a[48:51], v[52:55]
    v_cvt_pk_bf16_f32 v66, v244, v245
    v_cvt_pk_bf16_f32 v67, v246, v247
    v_mfma_f32_16x16x32_bf16 v[52:55], a[180:183], a[52:55], v[52:55]
    v_mfma_f32_16x16x32_bf16 v[52:55], a[184:187], a[56:59], v[52:55]
    buffer_store_dwordx4 v[64:67], v248, s[40:43], s63 offen sc1
    v_mfma_f32_16x16x32_bf16 v[52:55], a[188:191], a[60:63], v[52:55]
    s_cmp_eq_u32 s42, 0
    s_cbranch_scc1 L_own14
    L_ownb14:
    v_mfma_f32_16x16x32_bf16 v[56:59], a[192:195], a[32:35], 0
    v_mfma_f32_16x16x32_bf16 v[56:59], a[196:199], a[36:39], v[56:59]
    v_mfma_f32_16x16x32_bf16 v[56:59], a[200:203], a[40:43], v[56:59]
    v_mul_f32 v52, v37, v52
    v_mul_f32 v53, v37, v53
    v_mfma_f32_16x16x32_bf16 v[56:59], a[204:207], a[44:47], v[56:59]
    v_mul_f32 v54, v37, v54
    v_mul_f32 v55, v37, v55
    v_mfma_f32_16x16x32_bf16 v[56:59], a[208:211], a[48:51], v[56:59]
    v_cvt_pk_bf16_f32 v32, v52, v53
    v_cvt_pk_bf16_f32 v33, v54, v55
    v_mfma_f32_16x16x32_bf16 v[56:59], a[212:215], a[52:55], v[56:59]
    v_mfma_f32_16x16x32_bf16 v[56:59], a[216:219], a[56:59], v[56:59]
    s_cmp_eq_u32 s71, 3
    s_cselect_b32 s42, 0, s69
    v_mfma_f32_16x16x32_bf16 v[56:59], a[220:223], a[60:63], v[56:59]
    v_mfma_f32_16x16x32_bf16 v[92:95], a[160:163], a[64:67], 0
    s_xor_b32 s63, s57, 31465472
    v_mfma_f32_16x16x32_bf16 v[92:95], a[164:167], a[68:71], v[92:95]
    v_mfma_f32_16x16x32_bf16 v[92:95], a[168:171], a[72:75], v[92:95]
    v_mul_f32 v56, v37, v56
    v_mul_f32 v57, v37, v57
    v_mfma_f32_16x16x32_bf16 v[92:95], a[172:175], a[76:79], v[92:95]
    v_mul_f32 v58, v37, v58
    v_mul_f32 v59, v37, v59
    v_mfma_f32_16x16x32_bf16 v[92:95], a[176:179], a[80:83], v[92:95]
    v_cvt_pk_bf16_f32 v34, v56, v57
    v_cvt_pk_bf16_f32 v35, v58, v59
    v_mfma_f32_16x16x32_bf16 v[92:95], a[180:183], a[84:87], v[92:95]
    v_mfma_f32_16x16x32_bf16 v[92:95], a[184:187], a[88:91], v[92:95]
    buffer_store_dwordx4 v[32:35], v248, s[40:43], s63 offen sc1
    v_mfma_f32_16x16x32_bf16 v[92:95], a[188:191], a[92:95], v[92:95]
    s_cmp_eq_u32 s42, 0
    s_cbranch_scc1 L_own15
    L_ownb15:
    v_mfma_f32_16x16x32_bf16 v[240:243], a[192:195], a[64:67], 0
    v_mfma_f32_16x16x32_bf16 v[240:243], a[196:199], a[68:71], v[240:243]
    v_mfma_f32_16x16x32_bf16 v[240:243], a[200:203], a[72:75], v[240:243]
    s_waitcnt vmcnt(4)
    v_mul_f32 v92, v38, v92
    v_mul_f32 v93, v38, v93
    v_mfma_f32_16x16x32_bf16 v[240:243], a[204:207], a[76:79], v[240:243]
    s_barrier
    v_mul_f32 v94, v38, v94
    v_mul_f32 v95, v38, v95
    v_mfma_f32_16x16x32_bf16 v[240:243], a[208:211], a[80:83], v[240:243]
    v_cvt_pk_bf16_f32 v64, v92, v93
    v_cvt_pk_bf16_f32 v65, v94, v95
    v_mfma_f32_16x16x32_bf16 v[240:243], a[212:215], a[84:87], v[240:243]
    s_nop 0
    ds_read_b64_tr_b16 v[128:129], v250 offset:0
    ds_read_b64_tr_b16 v[130:131], v250 offset:2048
    v_mfma_f32_16x16x32_bf16 v[240:243], a[216:219], a[88:91], v[240:243]
    s_cmp_eq_u32 s71, 0
    s_cselect_b32 s42, 0, s69
    ds_read_b64_tr_b16 v[132:133], v250 offset:4096
    ds_read_b64_tr_b16 v[134:135], v250 offset:6144
    v_mfma_f32_16x16x32_bf16 v[240:243], a[220:223], a[92:95], v[240:243]
    s_nop 0
    ds_read_b64_tr_b16 v[136:137], v250 offset:8192
    ds_read_b64_tr_b16 v[138:139], v250 offset:10240
    v_mfma_f32_16x16x32_bf16 v[244:247], a[160:163], a[96:99], 0
    s_xor_b32 s63, s57, 33554432
    ds_read_b64_tr_b16 v[140:141], v250 offset:12288
    ds_read_b64_tr_b16 v[142:143], v250 offset:14336
    v_mfma_f32_16x16x32_bf16 v[244:247], a[164:167], a[100:103], v[244:247]
    s_nop 0
    ds_read_b64_tr_b16 v[144:145], v250 offset:16384
    ds_read_b64_tr_b16 v[146:147], v250 offset:18432
    v_mfma_f32_16x16x32_bf16 v[244:247], a[168:171], a[104:107], v[244:247]
    v_mul_f32 v240, v38, v240
    v_mul_f32 v241, v38, v241
    v_mfma_f32_16x16x32_bf16 v[244:247], a[172:175], a[108:111], v[244:247]
    v_mul_f32 v242, v38, v242
    v_mul_f32 v243, v38, v243
    v_mfma_f32_16x16x32_bf16 v[244:247], a[176:179], a[112:115], v[244:247]
    v_cvt_pk_bf16_f32 v66, v240, v241
    v_cvt_pk_bf16_f32 v67, v242, v243
    v_mfma_f32_16x16x32_bf16 v[244:247], a[180:183], a[116:119], v[244:247]
    s_nop 0
    ds_read_b64_tr_b16 v[148:149], v250 offset:20480
    ds_read_b64_tr_b16 v[150:151], v250 offset:22528
    v_mfma_f32_16x16x32_bf16 v[244:247], a[184:187], a[120:123], v[244:247]
    buffer_store_dwordx4 v[64:67], v248, s[40:43], s63 offen sc1
    v_mfma_f32_16x16x32_bf16 v[244:247], a[188:191], a[124:127], v[244:247]
    s_cmp_eq_u32 s42, 0
    s_cbranch_scc1 L_own16
    L_ownb16:
    ds_read_b64_tr_b16 v[152:153], v250 offset:24576
    ds_read_b64_tr_b16 v[154:155], v250 offset:26624
    v_mfma_f32_16x16x32_bf16 v[52:55], a[192:195], a[96:99], 0
    s_nop 0
    ds_read_b64_tr_b16 v[156:157], v250 offset:28672
    ds_read_b64_tr_b16 v[158:159], v250 offset:30720
    v_mfma_f32_16x16x32_bf16 v[52:55], a[196:199], a[100:103], v[52:55]
    v_mfma_f32_16x16x32_bf16 v[52:55], a[200:203], a[104:107], v[52:55]
    v_mul_f32 v244, v39, v244
    v_mul_f32 v245, v39, v245
    v_mfma_f32_16x16x32_bf16 v[52:55], a[204:207], a[108:111], v[52:55]
    v_mul_f32 v246, v39, v246
    v_mul_f32 v247, v39, v247
    v_mfma_f32_16x16x32_bf16 v[52:55], a[208:211], a[112:115], v[52:55]
    v_cvt_pk_bf16_f32 v32, v244, v245
    v_cvt_pk_bf16_f32 v33, v246, v247
    v_mfma_f32_16x16x32_bf16 v[52:55], a[212:215], a[116:119], v[52:55]
    v_mfma_f32_16x16x32_bf16 v[52:55], a[216:219], a[120:123], v[52:55]
    s_cmp_eq_u32 s71, 1
    s_cselect_b32 s42, 0, s69
    v_mfma_f32_16x16x32_bf16 v[52:55], a[220:223], a[124:127], v[52:55]
    v_mfma_f32_16x16x32_bf16 v[56:59], a[160:163], a[128:131], 0
    s_xor_b32 s63, s57, 35659776
    v_mfma_f32_16x16x32_bf16 v[56:59], a[164:167], a[132:135], v[56:59]
    v_mfma_f32_16x16x32_bf16 v[56:59], a[168:171], a[136:139], v[56:59]
    v_mul_f32 v52, v39, v52
    v_mul_f32 v53, v39, v53
    v_mfma_f32_16x16x32_bf16 v[56:59], a[172:175], a[140:143], v[56:59]
    v_mul_f32 v54, v39, v54
    v_mul_f32 v55, v39, v55
    v_mfma_f32_16x16x32_bf16 v[56:59], a[176:179], a[144:147], v[56:59]
    v_cvt_pk_bf16_f32 v34, v52, v53
    v_cvt_pk_bf16_f32 v35, v54, v55
    v_mfma_f32_16x16x32_bf16 v[56:59], a[180:183], a[148:151], v[56:59]
    v_mfma_f32_16x16x32_bf16 v[56:59], a[184:187], a[152:155], v[56:59]
    buffer_store_dwordx4 v[32:35], v248, s[40:43], s63 offen sc1
    v_mfma_f32_16x16x32_bf16 v[56:59], a[188:191], a[156:159], v[56:59]
    s_cmp_eq_u32 s42, 0
    s_cbranch_scc1 L_own17
    L_ownb17:
    v_mfma_f32_16x16x32_bf16 v[92:95], a[192:195], a[128:131], 0
    v_mfma_f32_16x16x32_bf16 v[92:95], a[196:199], a[132:135], v[92:95]
    v_mfma_f32_16x16x32_bf16 v[92:95], a[200:203], a[136:139], v[92:95]
    v_mul_f32 v56, v40, v56
    v_mul_f32 v57, v40, v57
    v_mfma_f32_16x16x32_bf16 v[92:95], a[204:207], a[140:143], v[92:95]
    v_mul_f32 v58, v40, v58
    v_mul_f32 v59, v40, v59
    v_mfma_f32_16x16x32_bf16 v[92:95], a[208:211], a[144:147], v[92:95]
    v_cvt_pk_bf16_f32 v64, v56, v57
    v_cvt_pk_bf16_f32 v65, v58, v59
    v_mfma_f32_16x16x32_bf16 v[92:95], a[212:215], a[148:151], v[92:95]
    v_mfma_f32_16x16x32_bf16 v[92:95], a[216:219], a[152:155], v[92:95]
    s_cmp_eq_u32 s71, 2
    s_cselect_b32 s42, 0, s69
    v_mfma_f32_16x16x32_bf16 v[92:95], a[220:223], a[156:159], v[92:95]
    v_mfma_f32_16x16x32_bf16 v[240:243], a[160:163], a[224:227], 0
    s_xor_b32 s63, s57, 37748736
    v_mfma_f32_16x16x32_bf16 v[240:243], a[164:167], a[228:231], v[240:243]
    v_mfma_f32_16x16x32_bf16 v[240:243], a[168:171], a[232:235], v[240:243]
    v_mul_f32 v92, v40, v92
    v_mul_f32 v93, v40, v93
    v_mfma_f32_16x16x32_bf16 v[240:243], a[172:175], a[236:239], v[240:243]
    v_mul_f32 v94, v40, v94
    v_mul_f32 v95, v40, v95
    v_mfma_f32_16x16x32_bf16 v[240:243], a[176:179], a[240:243], v[240:243]
    v_cvt_pk_bf16_f32 v66, v92, v93
    v_cvt_pk_bf16_f32 v67, v94, v95
    v_mfma_f32_16x16x32_bf16 v[240:243], a[180:183], a[244:247], v[240:243]
    v_mfma_f32_16x16x32_bf16 v[240:243], a[184:187], a[248:251], v[240:243]
    buffer_store_dwordx4 v[64:67], v248, s[40:43], s63 offen sc1
    v_mfma_f32_16x16x32_bf16 v[240:243], a[188:191], a[252:255], v[240:243]
    s_cmp_eq_u32 s42, 0
    s_cbranch_scc1 L_own18
    L_ownb18:
    v_mfma_f32_16x16x32_bf16 v[244:247], a[192:195], a[224:227], 0
    v_mfma_f32_16x16x32_bf16 v[244:247], a[196:199], a[228:231], v[244:247]
    v_mfma_f32_16x16x32_bf16 v[244:247], a[200:203], a[232:235], v[244:247]
    v_mul_f32 v240, v41, v240
    v_mul_f32 v241, v41, v241
    v_mfma_f32_16x16x32_bf16 v[244:247], a[204:207], a[236:239], v[244:247]
    v_mul_f32 v242, v41, v242
    v_mul_f32 v243, v41, v243
    v_mfma_f32_16x16x32_bf16 v[244:247], a[208:211], a[240:243], v[244:247]
    v_cvt_pk_bf16_f32 v32, v240, v241
    v_cvt_pk_bf16_f32 v33, v242, v243
    v_mfma_f32_16x16x32_bf16 v[244:247], a[212:215], a[244:247], v[244:247]
    v_mfma_f32_16x16x32_bf16 v[244:247], a[216:219], a[248:251], v[244:247]
    s_cmp_eq_u32 s71, 3
    s_cselect_b32 s42, 0, s69
    v_mfma_f32_16x16x32_bf16 v[244:247], a[220:223], a[252:255], v[244:247]
    v_mfma_f32_16x16x32_bf16 v[52:55], a[160:163], v[96:99], 0
    s_xor_b32 s63, s57, 39854080
    v_mfma_f32_16x16x32_bf16 v[52:55], a[164:167], v[100:103], v[52:55]
    v_mfma_f32_16x16x32_bf16 v[52:55], a[168:171], v[104:107], v[52:55]
    v_mul_f32 v244, v41, v244
    v_mul_f32 v245, v41, v245
    v_mfma_f32_16x16x32_bf16 v[52:55], a[172:175], v[108:111], v[52:55]
    v_mul_f32 v246, v41, v246
    v_mul_f32 v247, v41, v247
    v_mfma_f32_16x16x32_bf16 v[52:55], a[176:179], v[112:115], v[52:55]
    v_cvt_pk_bf16_f32 v34, v244, v245
    v_cvt_pk_bf16_f32 v35, v246, v247
    v_mfma_f32_16x16x32_bf16 v[52:55], a[180:183], v[116:119], v[52:55]
    v_mfma_f32_16x16x32_bf16 v[52:55], a[184:187], v[120:123], v[52:55]
    buffer_store_dwordx4 v[32:35], v248, s[40:43], s63 offen sc1
    v_mfma_f32_16x16x32_bf16 v[52:55], a[188:191], v[124:127], v[52:55]
    s_cmp_eq_u32 s42, 0
    s_cbranch_scc1 L_own19
    L_ownb19:
    v_mfma_f32_16x16x32_bf16 v[56:59], a[192:195], v[96:99], 0
    v_mfma_f32_16x16x32_bf16 v[56:59], a[196:199], v[100:103], v[56:59]
    v_mfma_f32_16x16x32_bf16 v[56:59], a[200:203], v[104:107], v[56:59]
    v_mul_f32 v52, v42, v52
    v_mul_f32 v53, v42, v53
    v_mfma_f32_16x16x32_bf16 v[56:59], a[204:207], v[108:111], v[56:59]
    v_mul_f32 v54, v42, v54
    v_mul_f32 v55, v42, v55
    v_mfma_f32_16x16x32_bf16 v[56:59], a[208:211], v[112:115], v[56:59]
    v_cvt_pk_bf16_f32 v64, v52, v53
    v_cvt_pk_bf16_f32 v65, v54, v55
    v_mfma_f32_16x16x32_bf16 v[56:59], a[212:215], v[116:119], v[56:59]
    v_mfma_f32_16x16x32_bf16 v[56:59], a[216:219], v[120:123], v[56:59]
    s_cmp_eq_u32 s71, 0
    s_cselect_b32 s42, 0, s69
    v_mfma_f32_16x16x32_bf16 v[56:59], a[220:223], v[124:127], v[56:59]
    s_waitcnt lgkmcnt(0)
    v_mfma_f32_16x16x32_bf16 v[92:95], v[128:131], a[0:3], 0
    s_xor_b32 s63, s57, 41943040
    v_mfma_f32_16x16x32_bf16 v[92:95], v[132:135], a[4:7], v[92:95]
    v_mfma_f32_16x16x32_bf16 v[92:95], v[136:139], a[8:11], v[92:95]
    v_mul_f32 v56, v42, v56
    v_mul_f32 v57, v42, v57
    v_mfma_f32_16x16x32_bf16 v[92:95], v[140:143], a[12:15], v[92:95]
    v_mul_f32 v58, v42, v58
    v_mul_f32 v59, v42, v59
    v_mfma_f32_16x16x32_bf16 v[92:95], v[144:147], a[16:19], v[92:95]
    v_cvt_pk_bf16_f32 v66, v56, v57
    v_cvt_pk_bf16_f32 v67, v58, v59
    v_mfma_f32_16x16x32_bf16 v[92:95], v[148:151], a[20:23], v[92:95]
    v_mfma_f32_16x16x32_bf16 v[92:95], v[152:155], a[24:27], v[92:95]
    buffer_store_dwordx4 v[64:67], v248, s[40:43], s63 offen sc1
    v_mfma_f32_16x16x32_bf16 v[92:95], v[156:159], a[28:31], v[92:95]
    s_cmp_eq_u32 s42, 0
    s_cbranch_scc1 L_own20
    L_ownb20:
    v_mfma_f32_16x16x32_bf16 v[240:243], v[128:131], a[32:35], 0
    v_mfma_f32_16x16x32_bf16 v[240:243], v[132:135], a[36:39], v[240:243]
    v_mfma_f32_16x16x32_bf16 v[240:243], v[136:139], a[40:43], v[240:243]
    v_mul_f32 v92, v36, v92
    v_mul_f32 v93, v36, v93
    v_mfma_f32_16x16x32_bf16 v[240:243], v[140:143], a[44:47], v[240:243]
    v_mul_f32 v94, v36, v94
    v_mul_f32 v95, v36, v95
    v_mfma_f32_16x16x32_bf16 v[240:243], v[144:147], a[48:51], v[240:243]
    v_cvt_pk_bf16_f32 v32, v92, v93
    v_cvt_pk_bf16_f32 v33, v94, v95
    v_mfma_f32_16x16x32_bf16 v[240:243], v[148:151], a[52:55], v[240:243]
    v_mfma_f32_16x16x32_bf16 v[240:243], v[152:155], a[56:59], v[240:243]
    s_cmp_eq_u32 s71, 1
    s_cselect_b32 s42, 0, s69
    v_mfma_f32_16x16x32_bf16 v[240:243], v[156:159], a[60:63], v[240:243]
    v_mfma_f32_16x16x32_bf16 v[244:247], v[128:131], a[64:67], 0
    s_xor_b32 s63, s57, 44048384
    v_mfma_f32_16x16x32_bf16 v[244:247], v[132:135], a[68:71], v[244:247]
    v_mfma_f32_16x16x32_bf16 v[244:247], v[136:139], a[72:75], v[244:247]
    v_mul_f32 v240, v37, v240
    v_mul_f32 v241, v37, v241
    v_mfma_f32_16x16x32_bf16 v[244:247], v[140:143], a[76:79], v[244:247]
    v_mul_f32 v242, v37, v242
    v_mul_f32 v243, v37, v243
    v_mfma_f32_16x16x32_bf16 v[244:247], v[144:147], a[80:83], v[244:247]
    v_cvt_pk_bf16_f32 v34, v240, v241
    v_cvt_pk_bf16_f32 v35, v242, v243
    v_mfma_f32_16x16x32_bf16 v[244:247], v[148:151], a[84:87], v[244:247]
    v_mfma_f32_16x16x32_bf16 v[244:247], v[152:155], a[88:91], v[244:247]
    buffer_store_dwordx4 v[32:35], v248, s[40:43], s63 offen sc1
    v_mfma_f32_16x16x32_bf16 v[244:247], v[156:159], a[92:95], v[244:247]
    s_cmp_eq_u32 s42, 0
    s_cbranch_scc1 L_own21
    L_ownb21:
    v_mfma_f32_16x16x32_bf16 v[52:55], v[128:131], a[96:99], 0
    v_mfma_f32_16x16x32_bf16 v[52:55], v[132:135], a[100:103], v[52:55]
    v_mfma_f32_16x16x32_bf16 v[52:55], v[136:139], a[104:107], v[52:55]
    v_mul_f32 v244, v38, v244
    v_mul_f32 v245, v38, v245
    v_mfma_f32_16x16x32_bf16 v[52:55], v[140:143], a[108:111], v[52:55]
    v_mul_f32 v246, v38, v246
    v_mul_f32 v247, v38, v247
    v_mfma_f32_16x16x32_bf16 v[52:55], v[144:147], a[112:115], v[52:55]
    v_cvt_pk_bf16_f32 v64, v244, v245
    v_cvt_pk_bf16_f32 v65, v246, v247
    v_mfma_f32_16x16x32_bf16 v[52:55], v[148:151], a[116:119], v[52:55]
    s_cmp_lg_u32 s56, 0
    s_cbranch_scc1 L_np1
    s_mov_b32 s60, 0
    s_atomic_add s60, s[52:53], s57 glc
    L_np1:
    v_mfma_f32_16x16x32_bf16 v[52:55], v[152:155], a[120:123], v[52:55]
    s_cmp_eq_u32 s71, 2
    s_cselect_b32 s42, 0, s69
    v_mfma_f32_16x16x32_bf16 v[52:55], v[156:159], a[124:127], v[52:55]
    v_mfma_f32_16x16x32_bf16 v[56:59], v[128:131], a[128:131], 0
    s_xor_b32 s63, s57, 46137344
    v_mfma_f32_16x16x32_bf16 v[56:59], v[132:135], a[132:135], v[56:59]
    v_mfma_f32_16x16x32_bf16 v[56:59], v[136:139], a[136:139], v[56:59]
    v_mul_f32 v52, v39, v52
    v_mul_f32 v53, v39, v53
    v_mfma_f32_16x16x32_bf16 v[56:59], v[140:143], a[140:143], v[56:59]
    v_mul_f32 v54, v39, v54
    v_mul_f32 v55, v39, v55
    v_mfma_f32_16x16x32_bf16 v[56:59], v[144:147], a[144:147], v[56:59]
    v_cvt_pk_bf16_f32 v66, v52, v53
    v_cvt_pk_bf16_f32 v67, v54, v55
    v_mfma_f32_16x16x32_bf16 v[56:59], v[148:151], a[148:151], v[56:59]
    v_mfma_f32_16x16x32_bf16 v[56:59], v[152:155], a[152:155], v[56:59]
    buffer_store_dwordx4 v[64:67], v248, s[40:43], s63 offen sc1
    v_mfma_f32_16x16x32_bf16 v[56:59], v[156:159], a[156:159], v[56:59]
    s_cmp_eq_u32 s42, 0
    s_cbranch_scc1 L_own22
    L_ownb22:
    v_mfma_f32_16x16x32_bf16 v[92:95], v[128:131], a[224:227], 0
    v_mfma_f32_16x16x32_bf16 v[92:95], v[132:135], a[228:231], v[92:95]
    v_mfma_f32_16x16x32_bf16 v[92:95], v[136:139], a[232:235], v[92:95]
    v_mul_f32 v56, v40, v56
    v_mul_f32 v57, v40, v57
    v_mfma_f32_16x16x32_bf16 v[92:95], v[140:143], a[236:239], v[92:95]
    v_mul_f32 v58, v40, v58
    v_mul_f32 v59, v40, v59
    v_mfma_f32_16x16x32_bf16 v[92:95], v[144:147], a[240:243], v[92:95]
    v_cvt_pk_bf16_f32 v32, v56, v57
    v_cvt_pk_bf16_f32 v33, v58, v59
    v_mfma_f32_16x16x32_bf16 v[92:95], v[148:151], a[244:247], v[92:95]
    v_mfma_f32_16x16x32_bf16 v[92:95], v[152:155], a[248:251], v[92:95]
    s_cmp_eq_u32 s71, 3
    s_cselect_b32 s42, 0, s69
    v_mfma_f32_16x16x32_bf16 v[92:95], v[156:159], a[252:255], v[92:95]
    v_mfma_f32_16x16x32_bf16 v[240:243], v[128:131], v[96:99], 0
    s_xor_b32 s63, s57, 48242688
    v_mfma_f32_16x16x32_bf16 v[240:243], v[132:135], v[100:103], v[240:243]
    v_mfma_f32_16x16x32_bf16 v[240:243], v[136:139], v[104:107], v[240:243]
    v_mul_f32 v92, v41, v92
    v_mul_f32 v93, v41, v93
    v_mfma_f32_16x16x32_bf16 v[240:243], v[140:143], v[108:111], v[240:243]
    v_mul_f32 v94, v41, v94
    v_mul_f32 v95, v41, v95
    v_mfma_f32_16x16x32_bf16 v[240:243], v[144:147], v[112:115], v[240:243]
    v_cvt_pk_bf16_f32 v34, v92, v93
    v_cvt_pk_bf16_f32 v35, v94, v95
    v_mfma_f32_16x16x32_bf16 v[240:243], v[148:151], v[116:119], v[240:243]
    v_mfma_f32_16x16x32_bf16 v[240:243], v[152:155], v[120:123], v[240:243]
    buffer_store_dwordx4 v[32:35], v248, s[40:43], s63 offen sc1
    v_mfma_f32_16x16x32_bf16 v[240:243], v[156:159], v[124:127], v[240:243]
    s_cmp_eq_u32 s42, 0
    s_cbranch_scc1 L_own23
    L_ownb23:
    s_nop 4
    v_lshrrev_b32 v248, 5, v1
    v_lshlrev_b32 v248, 30, v248
    v_lshl_add_u32 v248, v0, 4, v248
    v_mul_f32 v240, v42, v240
    v_mul_f32 v241, v42, v241
    v_mul_f32 v242, v42, v242
    v_mul_f32 v243, v42, v243
    v_cvt_pk_bf16_f32 v64, v240, v241
    v_cvt_pk_bf16_f32 v65, v242, v243
    v_mov_b32 v66, v64
    v_mov_b32 v67, v65
    s_xor_b32 s63, s57, 50331648
    s_mov_b32 s42, s69
    v_permlane32_swap_b32 v64, v66
    v_permlane32_swap_b32 v65, v67
    buffer_store_dwordx4 v[64:67], v248, s[40:43], s63 offen sc1
    s_waitcnt lgkmcnt(0)
    s_waitcnt vmcnt(9)
    s_cmp_lg_u32 s56, 0
    s_cbranch_scc1 L_w0
    s_mov_b32 s62, 400000
    L_r0:
    s_waitcnt lgkmcnt(0)
    s_bitcmp1_b32 s60, 4
    s_cbranch_scc1 L_r0_d
    s_sub_u32 s62, s62, 1
    s_cbranch_scc1 L_r0_d
    s_mov_b32 s60, 0
    s_atomic_add s60, s[52:53], s57 glc
    s_branch L_r0
    L_r0_d:
    L_w0:
    s_barrier
    s_cmp_lg_u32 s56, 0
    s_cbranch_scc1 L_nf2
    s_mov_b32 s67, 0x100
    s_atomic_add s67, s[52:53], s57
    L_nf2:
    s_not_b64 exec, s[10:11]
    buffer_load_dwordx4 v[96:99], v80, s[44:47], s4 offen sc1
    s_mov_b64 exec, -1
    buffer_load_dwordx4 v[100:103], v80, s[44:47], s5 offen sc1
    buffer_load_dwordx4 v[104:107], v80, s[44:47], s6 offen sc1
    buffer_load_dwordx4 v[108:111], v80, s[44:47], s7 offen sc1
    v_add_u32 v80, 8388608, v80
    s_not_b64 exec, s[10:11]
    buffer_load_dwordx4 v[112:115], v80, s[44:47], s4 offen sc1
    s_mov_b64 exec, -1
    buffer_load_dwordx4 v[116:119], v80, s[44:47], s5 offen sc1
    buffer_load_dwordx4 v[120:123], v80, s[44:47], s6 offen sc1
    buffer_load_dwordx4 v[124:127], v80, s[44:47], s7 offen sc1
    v_add_u32 v80, 8388608, v80
    s_mov_b64 exec, s[10:11]
    ds_read_b128 v[96:99], v81 offset:6144
    ds_read_b128 v[112:115], v81 offset:7168
    ds_read_b128 v[128:131], v81 offset:4096
    ds_read_b128 v[144:147], v81 offset:5120
    ds_read_b128 v[160:163], v81 offset:0
    ds_read_b128 v[176:179], v81 offset:1024
    s_mov_b64 exec, -1
    s_mov_b32 s80, 0xffff0000
    s_mov_b32 s81, 0xffff0000
    v_and_b32 v77, 1, v3
    v_lshlrev_b32 v77, 4, v77
    v_mov_b32 v78, 0x3f80
    v_lshlrev_b32 v77, v77, v78
    v_lshrrev_b32 v78, 1, v3
    v_cmp_eq_u32 s[20:21], 0, v78
    v_cmp_eq_u32 s[22:23], 1, v78
    v_cmp_eq_u32 s[24:25], 2, v78
    v_cmp_eq_u32 s[26:27], 3, v78
    v_cmp_gt_u32 vcc, 2, v4
    v_mul_u32_u24 v79, 896, v3
    v_cndmask_b32 v72, 0, v77, s[20:21]
    v_cndmask_b32 v73, 0, v77, s[22:23]
    v_cndmask_b32 v74, 0, v77, s[24:25]
    v_cndmask_b32 v75, 0, v77, s[26:27]
    s_lshl_b32 s14, s12, 5
    v_lshl_add_u32 v79, v2, 3, v79
    v_add_u32 v79, s14, v79
    v_mov_b32 v83, 0x40000000
    v_cndmask_b32 v82, v83, v79, vcc
    s_add_u32 s28, s13, 0
    s_mul_i32 s29, s28, 37
    s_lshr_b32 s29, s29, 8
    s_mul_i32 s30, s29, 7
    s_sub_u32 s30, s28, s30
    s_lshl_b32 s29, s29, 1
    s_add_u32 s29, s29, s72
    s_add_u32 s31, s29, 1
    s_mov_b32 s32, s30
    s_sub_u32 s33, s29, 7
    s_cmp_ge_u32 s29, 7
    s_cselect_b32 s29, s33, s29
    s_lshl_b32 s29, s29, 7
    s_mul_i32 s33, s30, 14336
    s_add_u32 s29, s29, s33
    s_sub_u32 s33, s31, 7
    s_cmp_ge_u32 s31, 7
    s_cselect_b32 s31, s33, s31
    s_lshl_b32 s31, s31, 7
    s_mul_i32 s33, s32, 14336
    s_add_u32 s31, s31, s33
    v_mov_b32 v77, s29
    v_mov_b32 v78, s31
    v_cndmask_b32 v77, v77, v78, s[80:81]
    v_add_u32 v84, v82, v77
    s_add_u32 s28, s13, 4
    s_mul_i32 s29, s28, 37
    s_lshr_b32 s29, s29, 8
    s_mul_i32 s30, s29, 7
    s_sub_u32 s30, s28, s30
    s_lshl_b32 s29, s29, 1
    s_add_u32 s29, s29, s72
    s_add_u32 s31, s29, 1
    s_mov_b32 s32, s30
    s_sub_u32 s33, s29, 7
    s_cmp_ge_u32 s29, 7
    s_cselect_b32 s29, s33, s29
    s_lshl_b32 s29, s29, 7
    s_mul_i32 s33, s30, 14336
    s_add_u32 s29, s29, s33
    s_sub_u32 s33, s31, 7
    s_cmp_ge_u32 s31, 7
    s_cselect_b32 s31, s33, s31
    s_lshl_b32 s31, s31, 7
    s_mul_i32 s33, s32, 14336
    s_add_u32 s31, s31, s33
    v_mov_b32 v77, s29
    v_mov_b32 v78, s31
    v_cndmask_b32 v77, v77, v78, s[80:81]
    v_add_u32 v85, v82, v77
    s_add_u32 s28, s13, 8
    s_mul_i32 s29, s28, 37
    s_lshr_b32 s29, s29, 8
    s_mul_i32 s30, s29, 7
    s_sub_u32 s30, s28, s30
    s_lshl_b32 s29, s29, 1
    s_add_u32 s29, s29, s72
    s_add_u32 s31, s29, 1
    s_mov_b32 s32, s30
    s_sub_u32 s33, s29, 7
    s_cmp_ge_u32 s29, 7
    s_cselect_b32 s29, s33, s29
    s_lshl_b32 s29, s29, 7
    s_mul_i32 s33, s30, 14336
    s_add_u32 s29, s29, s33
    s_sub_u32 s33, s31, 7
    s_cmp_ge_u32 s31, 7
    s_cselect_b32 s31, s33, s31
    s_lshl_b32 s31, s31, 7
    s_mul_i32 s33, s32, 14336
    s_add_u32 s31, s31, s33
    v_mov_b32 v77, s29
    v_mov_b32 v78, s31
    v_cndmask_b32 v77, v77, v78, s[80:81]
    v_add_u32 v86, v82, v77
    s_cmp_lg_u32 s56, 0
    s_cbranch_scc1 L_w1
    s_mov_b32 s60, 0
    s_atomic_add s60, s[52:53], s57 glc
    L_w1:
    s_waitcnt vmcnt(8)
    s_barrier
    s_cmp_lg_u32 s56, 0
    s_cbranch_scc1 L_nf4
    s_mov_b32 s70, 0x1010000
    s_atomic_add s70, s[52:53], s57
    s_mov_b32 s62, 400000
    L_r1:
    s_waitcnt lgkmcnt(0)
    s_bitcmp1_b32 s60, 12
    s_cbranch_scc1 L_r1_d
    s_sub_u32 s62, s62, 1
    s_cbranch_scc1 L_r1_d
    s_mov_b32 s60, 0
    s_atomic_add s60, s[52:53], s57 glc
    s_branch L_r1
    L_r1_d:
    L_nf4:
    s_barrier
    s_cmp_lg_u32 s56, 0
    s_cbranch_scc1 L_w2
    s_mov_b32 s60, 0
    s_atomic_add s60, s[52:53], s57 glc
    L_w2:
    s_not_b64 exec, s[10:11]
    buffer_load_dwordx4 v[128:131], v80, s[44:47], s4 offen sc1
    s_mov_b64 exec, -1
    buffer_load_dwordx4 v[132:135], v80, s[44:47], s5 offen sc1
    buffer_load_dwordx4 v[136:139], v80, s[44:47], s6 offen sc1
    buffer_load_dwordx4 v[140:143], v80, s[44:47], s7 offen sc1
    v_add_u32 v80, 8388608, v80
    s_not_b64 exec, s[10:11]
    buffer_load_dwordx4 v[144:147], v80, s[44:47], s4 offen sc1
    s_mov_b64 exec, -1
    buffer_load_dwordx4 v[148:151], v80, s[44:47], s5 offen sc1
    buffer_load_dwordx4 v[152:155], v80, s[44:47], s6 offen sc1
    buffer_load_dwordx4 v[156:159], v80, s[44:47], s7 offen sc1
    v_add_u32 v80, 8388608, v80
    s_add_u32 s28, s13, 12
    s_mul_i32 s29, s28, 37
    s_lshr_b32 s29, s29, 8
    s_mul_i32 s30, s29, 7
    s_sub_u32 s30, s28, s30
    s_lshl_b32 s29, s29, 1
    s_add_u32 s29, s29, s72
    s_add_u32 s31, s29, 1
    s_mov_b32 s32, s30
    s_sub_u32 s33, s29, 7
    s_cmp_ge_u32 s29, 7
    s_cselect_b32 s29, s33, s29
    s_lshl_b32 s29, s29, 7
    s_mul_i32 s33, s30, 14336
    s_add_u32 s29, s29, s33
    s_sub_u32 s33, s31, 7
    s_cmp_ge_u32 s31, 7
    s_cselect_b32 s31, s33, s31
    s_lshl_b32 s31, s31, 7
    s_mul_i32 s33, s32, 14336
    s_add_u32 s31, s31, s33
    v_mov_b32 v77, s29
    v_mov_b32 v78, s31
    v_cndmask_b32 v77, v77, v78, s[80:81]
    v_add_u32 v87, v82, v77
    s_add_u32 s28, s13, 16
    s_mul_i32 s29, s28, 37
    s_lshr_b32 s29, s29, 8
    s_mul_i32 s30, s29, 7
    s_sub_u32 s30, s28, s30
    s_lshl_b32 s29, s29, 1
    s_add_u32 s29, s29, s72
    s_add_u32 s31, s29, 1
    s_mov_b32 s32, s30
    s_sub_u32 s33, s29, 7
    s_cmp_ge_u32 s29, 7
    s_cselect_b32 s29, s33, s29
    s_lshl_b32 s29, s29, 7
    s_mul_i32 s33, s30, 14336
    s_add_u32 s29, s29, s33
    s_sub_u32 s33, s31, 7
    s_cmp_ge_u32 s31, 7
    s_cselect_b32 s31, s33, s31
    s_lshl_b32 s31, s31, 7
    s_mul_i32 s33, s32, 14336
    s_add_u32 s31, s31, s33
    v_mov_b32 v77, s29
    v_mov_b32 v78, s31
    v_cndmask_b32 v77, v77, v78, s[80:81]
    v_add_u32 v88, v82, v77
    s_add_u32 s28, s13, 20
    s_mul_i32 s29, s28, 37
    s_lshr_b32 s29, s29, 8
    s_mul_i32 s30, s29, 7
    s_sub_u32 s30, s28, s30
    s_lshl_b32 s29, s29, 1
    s_add_u32 s29, s29, s72
    s_add_u32 s31, s29, 1
    s_mov_b32 s32, s30
    s_cmp_ge_u32 s28, 21
    s_cselect_b32 s33, 1, 0
    s_lshl_b32 s30, s30, s33
    s_add_u32 s32, s30, s33
    s_sub_u32 s31, s31, s33
    s_sub_u32 s33, s29, 7
    s_cmp_ge_u32 s29, 7
    s_cselect_b32 s29, s33, s29
    s_lshl_b32 s29, s29, 7
    s_mul_i32 s33, s30, 14336
    s_add_u32 s29, s29, s33
    s_sub_u32 s33, s31, 7
    s_cmp_ge_u32 s31, 7
    s_cselect_b32 s31, s33, s31
    s_lshl_b32 s31, s31, 7
    s_mul_i32 s33, s32, 14336
    s_add_u32 s31, s31, s33
    v_mov_b32 v77, s29
    v_mov_b32 v78, s31
    v_cndmask_b32 v77, v77, v78, s[80:81]
    v_add_u32 v89, v82, v77
    s_lshl_b32 s28, s13, 10
    s_lshl_b32 s29, s12, 8
    s_add_u32 s28, s28, s29
    s_add_u32 s28, s28, 50331648
    s_add_u32 s28, s28, s57
    s_lshl_b32 s29, s13, 5
    s_lshl_b32 s30, s12, 3
    s_add_u32 s29, s29, s30
    s_lshl_b32 s30, s78, 7
    s_add_u32 s29, s29, s30
    s_add_u32 s29, s29, 86016
    s_lshr_b32 s30, s12, 1
    s_or_b32 s30, s30, s56
    s_cselect_b32 s28, 0x40000000, s28
    s_cselect_b32 s29, 0x40000000, s29
    v_lshlrev_b32 v91, 4, v3
    v_lshl_add_u32 v91, v4, 15, v91
    v_add_u32 v91, s28, v91
    v_cmp_gt_u32 vcc, 2, v4
    v_mul_u32_u24 v90, 896, v3
    v_lshl_add_u32 v90, v4, 4, v90
    v_add_u32 v90, s29, v90
    v_cndmask_b32 v90, v83, v90, vcc
    s_cmp_lg_u32 s56, 0
    s_cbranch_scc1 L_w4
    s_mov_b32 s62, 400000
    L_r3:
    s_waitcnt lgkmcnt(0)
    s_bitcmp1_b32 s60, 28
    s_cbranch_scc1 L_r3_d
    s_sub_u32 s62, s62, 1
    s_cbranch_scc1 L_r3_d
    s_mov_b32 s60, 0
    s_atomic_add s60, s[52:53], s57 glc
    s_branch L_r3
    L_r3_d:
    L_w4:
    s_barrier
    s_not_b64 exec, s[10:11]
    buffer_load_dwordx4 v[160:163], v80, s[44:47], s4 offen sc1
    s_mov_b64 exec, -1
    buffer_load_dwordx4 v[164:167], v80, s[44:47], s5 offen sc1
    buffer_load_dwordx4 v[168:171], v80, s[44:47], s6 offen sc1
    buffer_load_dwordx4 v[172:175], v80, s[44:47], s7 offen sc1
    v_add_u32 v80, 8388608, v80
    s_not_b64 exec, s[10:11]
    buffer_load_dwordx4 v[176:179], v80, s[44:47], s4 offen sc1
    s_mov_b64 exec, -1
    buffer_load_dwordx4 v[180:183], v80, s[44:47], s5 offen sc1
    buffer_load_dwordx4 v[184:187], v80, s[44:47], s6 offen sc1
    buffer_load_dwordx4 v[188:191], v80, s[44:47], s7 offen sc1
    v_add_u32 v80, 8388608, v80
    buffer_load_dwordx4 v[192:195], v91, s[44:47], s4 offen sc1
    buffer_load_dwordx4 v[196:199], v91, s[44:47], s5 offen sc1
    buffer_load_dwordx4 v[200:203], v91, s[44:47], s6 offen sc1
    buffer_load_dwordx4 v[204:207], v91, s[44:47], s7 offen sc1
    s_waitcnt lgkmcnt(0)
    s_waitcnt vmcnt(24)
    v_mfma_f32_16x16x32_bf16 v[228:231], v[72:75], v[96:99], 0
    v_mfma_f32_16x16x32_bf16 v[228:231], v[72:75], v[100:103], v[228:231]
    v_mfma_f32_16x16x32_bf16 v[228:231], v[72:75], v[104:107], v[228:231]
    v_mfma_f32_16x16x32_bf16 v[228:231], v[72:75], v[108:111], v[228:231]
    s_waitcnt vmcnt(20)
    v_mfma_f32_16x16x32_bf16 v[232:235], v[72:75], v[112:115], 0
    v_mfma_f32_16x16x32_bf16 v[232:235], v[72:75], v[116:119], v[232:235]
    v_mfma_f32_16x16x32_bf16 v[232:235], v[72:75], v[120:123], v[232:235]
    v_mfma_f32_16x16x32_bf16 v[232:235], v[72:75], v[124:127], v[232:235]
    v_cvt_pk_bf16_f32 v228, v228, v229
    v_cvt_pk_bf16_f32 v229, v230, v231
    buffer_store_dwordx2 v[228:229], v84, s[48:51], 0 offen
    s_waitcnt vmcnt(17)
    v_mfma_f32_16x16x32_bf16 v[228:231], v[72:75], v[128:131], 0
    v_mfma_f32_16x16x32_bf16 v[228:231], v[72:75], v[132:135], v[228:231]
    v_mfma_f32_16x16x32_bf16 v[228:231], v[72:75], v[136:139], v[228:231]
    v_mfma_f32_16x16x32_bf16 v[228:231], v[72:75], v[140:143], v[228:231]
    v_cvt_pk_bf16_f32 v232, v232, v233
    v_cvt_pk_bf16_f32 v233, v234, v235
    buffer_store_dwordx2 v[232:233], v85, s[48:51], 0 offen
    s_waitcnt vmcnt(14)
    v_mfma_f32_16x16x32_bf16 v[232:235], v[72:75], v[144:147], 0
    v_mfma_f32_16x16x32_bf16 v[232:235], v[72:75], v[148:151], v[232:235]
    v_mfma_f32_16x16x32_bf16 v[232:235], v[72:75], v[152:155], v[232:235]
    v_mfma_f32_16x16x32_bf16 v[232:235], v[72:75], v[156:159], v[232:235]
    v_cvt_pk_bf16_f32 v228, v228, v229
    v_cvt_pk_bf16_f32 v229, v230, v231
    buffer_store_dwordx2 v[228:229], v86, s[48:51], 0 offen
    s_waitcnt vmcnt(11)
    v_mfma_f32_16x16x32_bf16 v[228:231], v[72:75], v[160:163], 0
    v_mfma_f32_16x16x32_bf16 v[228:231], v[72:75], v[164:167], v[228:231]
    v_mfma_f32_16x16x32_bf16 v[228:231], v[72:75], v[168:171], v[228:231]
    v_mfma_f32_16x16x32_bf16 v[228:231], v[72:75], v[172:175], v[228:231]
    v_cvt_pk_bf16_f32 v232, v232, v233
    v_cvt_pk_bf16_f32 v233, v234, v235
    buffer_store_dwordx2 v[232:233], v87, s[48:51], 0 offen
    s_waitcnt vmcnt(8)
    v_mfma_f32_16x16x32_bf16 v[232:235], v[72:75], v[176:179], 0
    v_mfma_f32_16x16x32_bf16 v[232:235], v[72:75], v[180:183], v[232:235]
    v_mfma_f32_16x16x32_bf16 v[232:235], v[72:75], v[184:187], v[232:235]
    v_mfma_f32_16x16x32_bf16 v[232:235], v[72:75], v[188:191], v[232:235]
    v_cvt_pk_bf16_f32 v228, v228, v229
    v_cvt_pk_bf16_f32 v229, v230, v231
    buffer_store_dwordx2 v[228:229], v88, s[48:51], 0 offen
    s_waitcnt vmcnt(5)
    v_mfma_f32_16x16x32_bf16 v[228:231], v[72:75], v[192:195], 0
    v_mfma_f32_16x16x32_bf16 v[228:231], v[72:75], v[196:199], v[228:231]
    v_mfma_f32_16x16x32_bf16 v[228:231], v[72:75], v[200:203], v[228:231]
    v_mfma_f32_16x16x32_bf16 v[228:231], v[72:75], v[204:207], v[228:231]
    v_cvt_pk_bf16_f32 v232, v232, v233
    v_cvt_pk_bf16_f32 v233, v234, v235
    buffer_store_dwordx2 v[232:233], v89, s[48:51], 0 offen
    s_nop 5
    v_cvt_pk_bf16_f32 v228, v228, v229
    v_cvt_pk_bf16_f32 v229, v230, v231
    buffer_store_dwordx2 v[228:229], v90, s[48:51], 0 offen
L_end:
    s_endpgm
L_certspin:
    s_mov_b32 s62, 400000
L_certspin1:
    global_load_dword v7, v5, s[16:17] sc1
    s_sub_u32 s62, s62, 1
    s_cmp_eq_u32 s62, 0
    s_waitcnt vmcnt(0)
    s_cbranch_scc1 L_certok
    v_cmp_eq_u32 vcc, 0, v7
    s_cbranch_vccnz L_certspin1
    s_branch L_certok
L_own0:
    ds_write_b128 v249, v[64:67] offset:6144
    s_branch L_ownb0
L_own1:
    ds_write_b128 v249, v[32:35] offset:6144
    s_branch L_ownb1
L_own2:
    ds_write_b128 v249, v[64:67] offset:6144
    s_branch L_ownb2
L_own3:
    ds_write_b128 v249, v[32:35] offset:6144
    s_branch L_ownb3
L_own4:
    ds_write_b128 v249, v[64:67] offset:7168
    s_branch L_ownb4
L_own5:
    ds_write_b128 v249, v[32:35] offset:7168
    s_branch L_ownb5
L_own6:
    ds_write_b128 v249, v[64:67] offset:7168
    s_branch L_ownb6
L_own7:
    ds_write_b128 v249, v[32:35] offset:7168
    s_branch L_ownb7
L_own8:
    ds_write_b128 v249, v[64:67] offset:4096
    s_branch L_ownb8
L_own9:
    ds_write_b128 v249, v[32:35] offset:4096
    s_branch L_ownb9
L_own10:
    ds_write_b128 v249, v[64:67] offset:4096
    s_branch L_ownb10
L_own11:
    ds_write_b128 v249, v[32:35] offset:4096
    s_branch L_ownb11
L_own12:
    ds_write_b128 v249, v[64:67] offset:5120
    s_branch L_ownb12
L_own13:
    ds_write_b128 v249, v[32:35] offset:5120
    s_branch L_ownb13
L_own14:
    ds_write_b128 v249, v[64:67] offset:5120
    s_branch L_ownb14
L_own15:
    ds_write_b128 v249, v[32:35] offset:5120
    s_branch L_ownb15
L_own16:
    ds_write_b128 v249, v[64:67] offset:0
    s_branch L_ownb16
L_own17:
    ds_write_b128 v249, v[32:35] offset:0
    s_branch L_ownb17
L_own18:
    ds_write_b128 v249, v[64:67] offset:0
    s_branch L_ownb18
L_own19:
    ds_write_b128 v249, v[32:35] offset:0
    s_branch L_ownb19
L_own20:
    ds_write_b128 v249, v[64:67] offset:1024
    s_branch L_ownb20
L_own21:
    ds_write_b128 v249, v[32:35] offset:1024
    s_branch L_ownb21
L_own22:
    ds_write_b128 v249, v[64:67] offset:1024
    s_branch L_ownb22
L_own23:
    ds_write_b128 v249, v[32:35] offset:1024
    s_branch L_ownb23
L_fallback:
    s_cmp_lg_u32 s66, 0
    s_cbranch_scc1 L_nofb
    s_waitcnt vmcnt(0) lgkmcnt(0)
    s_barrier
    s_mov_b32 s66, 1
    s_branch L_restart
L_truemax:
    s_waitcnt vmcnt(0) lgkmcnt(0)
    s_barrier
    s_mov_b32 s65, 0
    s_mov_b32 s62, 16
    v_add_u32 v196, 0x10000, v16
    v_add_u32 v197, 0x10000, v17
    v_add_u32 v198, 0x10000, v18
    v_add_u32 v199, 0x10000, v19
L_tm_loop:
    s_add_u32 m0, s64, 65536
    s_nop 0
    buffer_load_dwordx4 v24, s[28:31], s65 offen offset:0 lds
    buffer_load_dwordx4 v25, s[28:31], s65 offen offset:1024 lds
    buffer_load_dwordx4 v26, s[28:31], s65 offen offset:2048 lds
    buffer_load_dwordx4 v27, s[28:31], s65 offen offset:3072 lds
    s_add_u32 m0, s64, 69632
    s_add_u32 s65, s65, 16384
    buffer_load_dwordx4 v28, s[28:31], s65 offen offset:0 lds
    buffer_load_dwordx4 v29, s[28:31], s65 offen offset:1024 lds
    buffer_load_dwordx4 v30, s[28:31], s65 offen offset:2048 lds
    buffer_load_dwordx4 v31, s[28:31], s65 offen offset:3072 lds
    s_add_u32 s65, s65, 16384
    s_waitcnt vmcnt(0)
    ds_read_b128 v[128:131], v196 offset:0
    ds_read_b128 v[132:135], v197 offset:0
    ds_read_b128 v[136:139], v198 offset:0
    ds_read_b128 v[140:143], v199 offset:0
    ds_read_b128 v[144:147], v196 offset:256
    ds_read_b128 v[148:151], v197 offset:256
    ds_read_b128 v[152:155], v198 offset:256
    ds_read_b128 v[156:159], v199 offset:256
    s_waitcnt lgkmcnt(0)
    v_mfma_f32_16x16x32_bf16 v[160:163], v[128:131], a[0:3], 0
    v_mfma_f32_16x16x32_bf16 v[160:163], v[132:135], a[4:7], v[160:163]
    v_mfma_f32_16x16x32_bf16 v[160:163], v[136:139], a[8:11], v[160:163]
    v_mfma_f32_16x16x32_bf16 v[160:163], v[140:143], a[12:15], v[160:163]
    v_mfma_f32_16x16x32_bf16 v[160:163], v[144:147], a[16:19], v[160:163]
    v_mfma_f32_16x16x32_bf16 v[160:163], v[148:151], a[20:23], v[160:163]
    v_mfma_f32_16x16x32_bf16 v[160:163], v[152:155], a[24:27], v[160:163]
    v_mfma_f32_16x16x32_bf16 v[160:163], v[156:159], a[28:31], v[160:163]
    v_mfma_f32_16x16x32_bf16 v[164:167], v[128:131], a[32:35], 0
    v_mfma_f32_16x16x32_bf16 v[164:167], v[132:135], a[36:39], v[164:167]
    v_mfma_f32_16x16x32_bf16 v[164:167], v[136:139], a[40:43], v[164:167]
    v_mfma_f32_16x16x32_bf16 v[164:167], v[140:143], a[44:47], v[164:167]
    v_mfma_f32_16x16x32_bf16 v[164:167], v[144:147], a[48:51], v[164:167]
    v_mfma_f32_16x16x32_bf16 v[164:167], v[148:151], a[52:55], v[164:167]
    v_mfma_f32_16x16x32_bf16 v[164:167], v[152:155], a[56:59], v[164:167]
    v_mfma_f32_16x16x32_bf16 v[164:167], v[156:159], a[60:63], v[164:167]
    v_mfma_f32_16x16x32_bf16 v[168:171], v[128:131], a[64:67], 0
    v_mfma_f32_16x16x32_bf16 v[168:171], v[132:135], a[68:71], v[168:171]
    v_mfma_f32_16x16x32_bf16 v[168:171], v[136:139], a[72:75], v[168:171]
    v_mfma_f32_16x16x32_bf16 v[168:171], v[140:143], a[76:79], v[168:171]
    v_mfma_f32_16x16x32_bf16 v[168:171], v[144:147], a[80:83], v[168:171]
    v_mfma_f32_16x16x32_bf16 v[168:171], v[148:151], a[84:87], v[168:171]
    v_mfma_f32_16x16x32_bf16 v[168:171], v[152:155], a[88:91], v[168:171]
    v_mfma_f32_16x16x32_bf16 v[168:171], v[156:159], a[92:95], v[168:171]
    v_mfma_f32_16x16x32_bf16 v[172:175], v[128:131], a[96:99], 0
    v_mfma_f32_16x16x32_bf16 v[172:175], v[132:135], a[100:103], v[172:175]
    v_mfma_f32_16x16x32_bf16 v[172:175], v[136:139], a[104:107], v[172:175]
    v_mfma_f32_16x16x32_bf16 v[172:175], v[140:143], a[108:111], v[172:175]
    v_mfma_f32_16x16x32_bf16 v[172:175], v[144:147], a[112:115], v[172:175]
    v_mfma_f32_16x16x32_bf16 v[172:175], v[148:151], a[116:119], v[172:175]
    v_mfma_f32_16x16x32_bf16 v[172:175], v[152:155], a[120:123], v[172:175]
    v_mfma_f32_16x16x32_bf16 v[172:175], v[156:159], a[124:127], v[172:175]
    v_mfma_f32_16x16x32_bf16 v[176:179], v[128:131], a[128:131], 0
    v_mfma_f32_16x16x32_bf16 v[176:179], v[132:135], a[132:135], v[176:179]
    v_mfma_f32_16x16x32_bf16 v[176:179], v[136:139], a[136:139], v[176:179]
    v_mfma_f32_16x16x32_bf16 v[176:179], v[140:143], a[140:143], v[176:179]
    v_mfma_f32_16x16x32_bf16 v[176:179], v[144:147], a[144:147], v[176:179]
    v_mfma_f32_16x16x32_bf16 v[176:179], v[148:151], a[148:151], v[176:179]
    v_mfma_f32_16x16x32_bf16 v[176:179], v[152:155], a[152:155], v[176:179]
    v_mfma_f32_16x16x32_bf16 v[176:179], v[156:159], a[156:159], v[176:179]
    v_mfma_f32_16x16x32_bf16 v[180:183], v[128:131], a[160:163], 0
    v_mfma_f32_16x16x32_bf16 v[180:183], v[132:135], a[164:167], v[180:183]
    v_mfma_f32_16x16x32_bf16 v[180:183], v[136:139], a[168:171], v[180:183]
    v_mfma_f32_16x16x32_bf16 v[180:183], v[140:143], a[172:175], v[180:183]
    v_mfma_f32_16x16x32_bf16 v[180:183], v[144:147], a[176:179], v[180:183]
    v_mfma_f32_16x16x32_bf16 v[180:183], v[148:151], a[180:183], v[180:183]
    v_mfma_f32_16x16x32_bf16 v[180:183], v[152:155], a[184:187], v[180:183]
    v_mfma_f32_16x16x32_bf16 v[180:183], v[156:159], a[188:191], v[180:183]
    v_mfma_f32_16x16x32_bf16 v[184:187], v[128:131], a[192:195], 0
    v_mfma_f32_16x16x32_bf16 v[184:187], v[132:135], a[196:199], v[184:187]
    v_mfma_f32_16x16x32_bf16 v[184:187], v[136:139], a[200:203], v[184:187]
    v_mfma_f32_16x16x32_bf16 v[184:187], v[140:143], a[204:207], v[184:187]
    v_mfma_f32_16x16x32_bf16 v[184:187], v[144:147], a[208:211], v[184:187]
    v_mfma_f32_16x16x32_bf16 v[184:187], v[148:151], a[212:215], v[184:187]
    v_mfma_f32_16x16x32_bf16 v[184:187], v[152:155], a[216:219], v[184:187]
    v_mfma_f32_16x16x32_bf16 v[184:187], v[156:159], a[220:223], v[184:187]
    s_nop 7
    s_nop 7
    v_max3_f32 v160, v160, v161, v162
    v_max_f32 v160, v160, v163
    ds_max_f32 v9, v160 offset:2048
    v_max3_f32 v164, v164, v165, v166
    v_max_f32 v164, v164, v167
    ds_max_f32 v9, v164 offset:2052
    v_max3_f32 v168, v168, v169, v170
    v_max_f32 v168, v168, v171
    ds_max_f32 v9, v168 offset:2056
    v_max3_f32 v172, v172, v173, v174
    v_max_f32 v172, v172, v175
    ds_max_f32 v9, v172 offset:2060
    v_max3_f32 v176, v176, v177, v178
    v_max_f32 v176, v176, v179
    ds_max_f32 v9, v176 offset:2064
    v_max3_f32 v180, v180, v181, v182
    v_max_f32 v180, v180, v183
    ds_max_f32 v9, v180 offset:2068
    v_max3_f32 v184, v184, v185, v186
    v_max_f32 v184, v184, v187
    ds_max_f32 v9, v184 offset:2072
    s_waitcnt lgkmcnt(0)
    s_sub_u32 s62, s62, 1
    s_cmp_lg_u32 s62, 0
    s_cbranch_scc1 L_tm_loop
L_last:
    s_branch L_truemax_done
.section .rodata,"a"
.p2align 6
.amdhsa_kernel standalone__mha_block_cached__near_ridge_kernel
  .amdhsa_next_free_vgpr 512
  .amdhsa_next_free_sgpr 102
  .amdhsa_accum_offset 256
  .amdhsa_group_segment_fixed_size 0
  .amdhsa_kernarg_size 64
  .amdhsa_user_sgpr_count 2
  .amdhsa_user_sgpr_kernarg_segment_ptr 1
  .amdhsa_system_sgpr_workgroup_id_x 1
.end_amdhsa_kernel
```
